```python
import torch

def _softmax(x, axis=-1):
    return torch.softmax(x, dim=axis)
def _gelu(x):
    return torch.nn.functional.gelu(x, approximate="tanh")
def _silu(x):
    return torch.nn.functional.silu(x)
def _sigmoid(x):
    return torch.sigmoid(x)
def _layernorm(x, axis=-1, eps=1e-5):
    m = x.mean(dim=axis, keepdim=True)
    v = x.var(dim=axis, keepdim=True, unbiased=False)
    return (x - m) / torch.sqrt(v + eps)
def _scatter_add(tgt, idx, src, axis=0):
    return tgt.clone().index_add_(axis, idx, src)
def _segment_sum(src, seg, n):
    out = torch.zeros((n,) + src.shape[1:], dtype=src.dtype)
    return out.index_add_(0, seg, src)
def _pad(x, pw):
    flat = tuple(v for pair in reversed(pw) for v in pair)
    return torch.nn.functional.pad(x, flat)

kernel_name = 'recurrent_scan__ssm_conv_h3__glu_gated_reglu__prompt'

def setup_inputs():

    _w = (lambda a: (lambda t: t.to(torch.bfloat16) if t.is_floating_point() else t)(torch.as_tensor(a)))
    def _A_setup():
        B, S, D = 1, 2048, 448
        ks = 4
        return {
            "q": _w((lambda *s: torch.randn(*s, dtype=torch.bfloat16) * 0.05)(B, S, D)),
            "k": _w((lambda *s: torch.randn(*s, dtype=torch.bfloat16) * 0.8)(B, S, D)),
            "v": _w((lambda *s: torch.randn(*s, dtype=torch.bfloat16) * 0.8)(B, S, D)),
            "shift_k": _w((lambda *s: torch.randn(*s, dtype=torch.bfloat16) * 0.8)(D, ks) * 0.5),
            "ssm_k": _w((lambda *s: torch.randn(*s, dtype=torch.bfloat16) * 0.8)(D, S) * (1.0 / S ** 0.5)),
            "ssm_D": _w((lambda *s: torch.randn(*s, dtype=torch.bfloat16) * 0.8)(D)),
        }
    _A_in = _A_setup()

    def _B_setup():
        B, S, D, F = 1, 2048, 448, 1792
        return {
            "x": _w((lambda *s: torch.randn(*s, dtype=torch.bfloat16) * 0.05)(B, S, D)),
            "W_gate": _w((lambda *s: torch.randn(*s, dtype=torch.bfloat16) * 0.2)(D, F) * (2.0 / D) ** 0.5),
            "W_up": _w((lambda *s: torch.randn(*s, dtype=torch.bfloat16) * 0.2)(D, F) * (2.0 / D) ** 0.5),
            "W_down": _w((lambda *s: torch.randn(*s, dtype=torch.bfloat16) * 0.2)(F, D) * (1.0 / F) ** 0.5),
        }
    _B_in = _B_setup()

    return {
        "A_q": _A_in["q"],
        "A_k": _A_in["k"],
        "A_v": _A_in["v"],
        "A_shift_k": _A_in["shift_k"],
        "A_ssm_k": _A_in["ssm_k"],
        "A_ssm_D": _A_in["ssm_D"],
        "B_x": _B_in["x"],
        "B_W_gate": _B_in["W_gate"],
        "B_W_up": _B_in["W_up"],
        "B_W_down": _B_in["W_down"],
    }

def reference(A_q, A_k, A_v, A_shift_k, A_ssm_k, A_ssm_D, B_x, B_W_gate, B_W_up, B_W_down):
    def _A_ref(q, k, v, shift_k, ssm_k, ssm_D):
        B, S, D = q.shape
        ks = shift_k.shape[-1]
        k_pad = _pad(k, ((0, 0), (ks - 1, 0), (0, 0)))
        k_shift = torch.zeros_like(k)
        for t in range(ks):
            k_shift = k_shift + k_pad[:, t:t + S, :] * shift_k[:, ks - 1 - t][None, None, :]
        kv = k_shift * v
        L = 2 * S
        kv_pad = _pad(kv, ((0, 0), (0, S), (0, 0)))
        kf_pad = _pad(ssm_k, ((0, 0), (0, S)))
        kv_f = (lambda x, axes=(-2,-1): torch.fft.rfft2(x.float(), dim=axes))(kv_pad[:, None, :, :], axes=(1, 2))
        kf_f = (lambda x, axes=(-2,-1): torch.fft.rfft2(x.float(), dim=axes))(kf_pad[:, None, :], axes=(1, 2))
        kf_f = (lambda x, *d: x.permute(*d))(kf_f, 1, 2, 0)
        y_f = kv_f * kf_f[None, :, :, :]
        y = (lambda x, s, axes=(-2,-1): torch.fft.irfft2(x, s=s, dim=axes).to(torch.bfloat16))(y_f, (1, L), axes=(1, 2))[:, 0, :S, :]
        y = y + kv * ssm_D[None, None, :]
        return q * y

    def _B_ref(x, W_gate, W_up, W_down):
        gate = torch.einsum("bsd,df->bsf", x, W_gate)
        up = torch.einsum("bsd,df->bsf", x, W_up)
        gate = gate * (lambda x, dt: x.to(dt))(gate > 0, gate.dtype)
        h = gate * up
        return torch.einsum("bsf,fd->bsd", h, W_down)

    x = A_q
    xn = _layernorm(x, axis=-1)
    s = _A_ref(xn, A_k, A_v, A_shift_k, A_ssm_k, A_ssm_D)
    g = _silu(_B_ref(xn, B_W_gate, B_W_up, B_W_down))
    return x + s * g
```

```asm
; @launch grid=(256,1,1) block=(512,1,1) lds=163840
.amdgcn_target "amdgcn-amd-amdhsa--gfx950"
.text
.globl recurrent_scan__ssm_conv_h3__glu_gated_reglu__prompt_kernel
.p2align 8
.type recurrent_scan__ssm_conv_h3__glu_gated_reglu__prompt_kernel,@function
recurrent_scan__ssm_conv_h3__glu_gated_reglu__prompt_kernel:
    s_cmp_ge_u32 s2, 256
    s_cbranch_scc1 K_END
    s_add_u32 s2, s2, 224
    s_and_b32 s2, s2, 255
    s_load_dwordx16 s[16:31], s[0:1], 0
    s_load_dwordx8 s[32:39], s[0:1], 64
    s_load_dwordx2 s[40:41], s[0:1], 96
    v_lshrrev_b32 v1, 6, v0
    v_and_b32 v2, 63, v0
    s_nop 0
    v_readfirstlane_b32 s3, v1
    s_cmp_ge_u32 s2, 224
    s_cbranch_scc1 K_PREP
    s_and_b32 s7, s2, 7
    s_lshr_b32 s8, s2, 3
    s_mul_i32 s4, s8, 37
    s_lshr_b32 s4, s4, 8
    s_mul_i32 s5, s4, 7
    s_sub_u32 s5, s8, s5
    s_mov_b32 s11, s5
    s_lshl_b32 s12, s7, 2
    s_add_u32 s12, s12, s4
    s_and_b32 s8, s7, 3
    s_lshl_b32 s8, s8, 2
    s_add_u32 s4, s4, s8
    s_lshr_b32 s8, s7, 2
    s_mul_i32 s8, s8, 7
    s_add_u32 s5, s5, s8
    s_and_b32 s10, s3, 3
    v_lshlrev_b32 v1, 4, v2
    v_mov_b32 v20, 0
    v_lshrrev_b32 v12, 3, v2
    v_lshrrev_b32 v13, 4, v2
    v_and_b32 v14, 7, v2
    s_lshl_b32 s7, s4, 7
    s_lshl_b32 s8, s10, 5
    s_add_u32 s7, s7, s8
    v_add_u32 v12, s7, v12
    v_mul_u32_u24 v12, 896, v12
    v_xor_b32 v15, v14, v13
    v_lshl_add_u32 v246, v15, 4, v12
    v_xor_b32 v15, 4, v15
    v_lshl_add_u32 v247, v15, 4, v12
    v_add_u32 v247, 7168, v247
    s_lshr_b32 s69, s10, 1
    s_and_b32 s68, s10, 1
    v_and_b32 v14, 15, v2
    v_lshlrev_b32 v15, 2, v13
    v_xor_b32 v14, v14, v15
    s_lshl_b32 s7, s69, 1
    v_xor_b32 v14, s7, v14
    s_lshl_b32 s8, s68, 5
    v_add_u32 v15, s8, v13
    v_mul_u32_u24 v15, 3584, v15
    v_lshl_add_u32 v248, v14, 4, v15
    s_lshl_b32 s7, s5, 8
    v_add_u32 v248, s7, v248
    s_lshl_b32 s13, s10, 12
    s_lshl_b32 s14, s10, 13
    s_add_u32 s14, s14, 16384
    s_mov_b32 s6, s12
    s_mov_b32 s9, s11
    s_waitcnt lgkmcnt(0)
    s_mov_b32 s44, s16
    s_and_b32 s45, s17, 0xffff
    s_mov_b32 s46, 1835008
    s_mov_b32 s47, 0x20000
    s_cmp_eq_u32 s69, 0
    s_cselect_b32 s48, s30, s32
    s_cselect_b32 s49, s31, s33
    s_and_b32 s49, s49, 0xffff
    s_mov_b32 s50, 1605632
    s_mov_b32 s51, 0x20000
    s_cmp_ge_u32 s3, 4
    s_cbranch_scc1 K_B
    s_mov_b32 s12, 0
    s_add_u32 m0, s14, 0
    s_nop 0
    buffer_load_dwordx4 v248, s[48:51], s12 offen lds
    s_mov_b32 s12, 14336
    s_add_u32 m0, s14, 1024
    s_nop 0
    buffer_load_dwordx4 v248, s[48:51], s12 offen lds
    s_mov_b32 s11, 0
    s_add_u32 m0, s13, 0
    s_nop 0
    buffer_load_dwordx4 v246, s[44:47], s11 offen lds
    s_mov_b32 s12, 28672
    s_add_u32 m0, s14, 2048
    s_nop 0
    buffer_load_dwordx4 v248, s[48:51], s12 offen lds
    s_mov_b32 s12, 43008
    s_add_u32 m0, s14, 3072
    s_nop 0
    buffer_load_dwordx4 v248, s[48:51], s12 offen lds
    s_mov_b32 s11, 0
    s_add_u32 m0, s13, 1024
    s_nop 0
    buffer_load_dwordx4 v247, s[44:47], s11 offen lds
    s_mov_b32 s12, 57344
    s_add_u32 m0, s14, 4096
    s_nop 0
    buffer_load_dwordx4 v248, s[48:51], s12 offen lds
    s_mov_b32 s12, 71680
    s_add_u32 m0, s14, 5120
    s_nop 0
    buffer_load_dwordx4 v248, s[48:51], s12 offen lds
    s_mov_b32 s11, 14336
    s_add_u32 m0, s13, 2048
    s_nop 0
    buffer_load_dwordx4 v246, s[44:47], s11 offen lds
    s_mov_b32 s12, 86016
    s_add_u32 m0, s14, 6144
    s_nop 0
    buffer_load_dwordx4 v248, s[48:51], s12 offen lds
    s_mov_b32 s12, 100352
    s_add_u32 m0, s14, 7168
    s_nop 0
    buffer_load_dwordx4 v248, s[48:51], s12 offen lds
    s_mov_b32 s11, 14336
    s_add_u32 m0, s13, 3072
    s_nop 0
    buffer_load_dwordx4 v247, s[44:47], s11 offen lds
    s_mov_b32 s76, s18
    s_and_b32 s77, s19, 0xffff
    s_mov_b32 s78, 1835008
    s_mov_b32 s79, 0x20000
    s_mov_b32 s80, s20
    s_and_b32 s81, s21, 0xffff
    s_mov_b32 s82, 1835008
    s_mov_b32 s83, 0x20000
    s_mov_b32 s84, s22
    s_and_b32 s85, s23, 0xffff
    s_mov_b32 s86, 3584
    s_mov_b32 s87, 0x20000
    v_lshrrev_b32 v88, 5, v2
    v_and_b32 v89, 31, v2
    s_lshl_b32 s8, s6, 3
    s_lshl_b32 s15, s10, 1
    s_add_u32 s8, s8, s15
    s_mul_i32 s8, s8, 7168
    s_lshl_b32 s7, s9, 7
    s_add_u32 s8, s8, s7
    v_mul_u32_u24 v90, 7168, v88
    v_lshl_add_u32 v90, v89, 2, v90
    v_add_u32 v90, s8, v90
    v_subrev_u32 v91, 2688, v90
    s_lshl_b32 s7, s7, 2
    v_lshl_add_u32 v93, v89, 4, s7
    s_mov_b32 s8, 3584
    buffer_load_dwordx4 v[116:119], v93, s[84:87], 0 offen
    buffer_load_dword v96, v91, s[76:79], 0 offen offset:0
    buffer_load_dword v97, v91, s[76:79], 0 offen offset:896
    buffer_load_dword v98, v91, s[76:79], 0 offen offset:1792
    buffer_load_dword v99, v90, s[76:79], 0 offen offset:0
    buffer_load_dword v100, v90, s[76:79], 0 offen offset:896
    buffer_load_dword v101, v90, s[76:79], 0 offen offset:1792
    buffer_load_dword v102, v90, s[76:79], 0 offen offset:2688
    buffer_load_dword v103, v90, s[76:79], s8 offen offset:0
    buffer_load_dword v104, v90, s[76:79], s8 offen offset:896
    buffer_load_dword v105, v90, s[76:79], s8 offen offset:1792
    buffer_load_dword v106, v90, s[76:79], s8 offen offset:2688
    buffer_load_dword v107, v90, s[80:83], 0 offen offset:0
    buffer_load_dword v108, v90, s[80:83], 0 offen offset:896
    buffer_load_dword v109, v90, s[80:83], 0 offen offset:1792
    buffer_load_dword v110, v90, s[80:83], 0 offen offset:2688
    buffer_load_dword v111, v90, s[80:83], s8 offen offset:0
    buffer_load_dword v112, v90, s[80:83], s8 offen offset:896
    buffer_load_dword v113, v90, s[80:83], s8 offen offset:1792
    buffer_load_dword v114, v90, s[80:83], s8 offen offset:2688
    s_mov_b32 s19, s9
    s_mov_b32 s18, s6
    v_and_b32 v12, 31, v2
    v_lshrrev_b32 v13, 5, v2
    v_bfe_u32 v14, v2, 1, 3
    v_xor_b32 v14, v14, v13
    v_lshlrev_b32 v15, 7, v12
    v_lshl_add_u32 v3, v14, 4, v15
    v_xor_b32 v4, 32, v3
    v_xor_b32 v5, 64, v3
    v_xor_b32 v6, 96, v3
    s_lshl_b32 s7, s4, 7
    v_add_u32 v12, s7, v12
    v_lshlrev_b32 v12, 3, v12
    v_add_u32 v24, 12582912, v12
    s_lshl_b32 s7, s5, 3
    s_lshl_b32 s8, s10, 1
    s_add_u32 s7, s7, s8
    s_lshl_b32 s8, s7, 7
    s_add_u32 s8, s8, 12599296
    v_lshl_add_u32 v25, v13, 4, s8
    s_lshl_b32 s8, s4, 9
    s_add_u32 s7, s7, s8
    s_lshl_b32 s7, s7, 10
    v_add_u32 v26, s7, v1
    v_bfe_u32 v12, v2, 4, 1
    v_bfe_u32 v14, v2, 2, 2
    v_bfe_u32 v15, v2, 1, 1
    s_lshl_b32 s7, s10, 2
    v_or_b32 v15, s7, v15
    v_lshlrev_b32 v16, 2, v14
    v_xor_b32 v15, v15, v16
    v_lshlrev_b32 v16, 1, v12
    v_xor_b32 v15, v15, v16
    v_lshlrev_b32 v15, 4, v15
    v_and_b32 v16, 1, v2
    v_lshl_add_u32 v15, v16, 3, v15
    v_lshl_add_u32 v14, v13, 3, v14
    v_lshl_add_u32 v15, v14, 8, v15
    v_add_u32 v12, 1, v12
    v_lshl_add_u32 v7, v12, 14, v15
    v_xor_b32 v8, 32, v7
    s_mul_i32 s6, s4, 56
    s_lshl_b32 s7, s5, 2
    s_add_u32 s6, s6, s7
    s_add_u32 s6, s6, s10
    s_lshl_b32 s6, s6, 7
    s_add_u32 s6, s6, 12845056
    s_lshl_b32 s29, s10, 12
    s_lshl_b32 s7, s18, 8
    s_mul_i32 s8, s10, 28
    s_add_u32 s7, s7, s8
    s_lshl_b32 s7, s7, 10
    v_add_u32 v19, s7, v1
    v_lshrrev_b32 v12, 3, v2
    s_mul_i32 s7, s10, 448
    v_add_u32 v12, s7, v12
    v_mul_u32_u24 v12, 896, v12
    v_bfe_u32 v13, v2, 4, 1
    v_lshlrev_b32 v13, 2, v13
    v_and_b32 v14, 7, v2
    v_xor_b32 v13, v13, v14
    v_lshl_add_u32 v0, v13, 4, v12
    s_lshl_b32 s7, s19, 7
    v_add_u32 v0, s7, v0
    v_lshrrev_b32 v12, 5, v2
    v_bfe_u32 v13, v2, 2, 2
    v_lshl_add_u32 v12, v12, 2, v13
    v_bfe_u32 v14, v2, 4, 1
    v_bfe_u32 v15, v2, 1, 1
    v_lshl_add_u32 v14, v14, 1, v15
    v_bfe_u32 v15, v2, 3, 1
    v_lshl_add_u32 v14, v15, 2, v14
    v_lshlrev_b32 v14, 4, v14
    v_and_b32 v15, 1, v2
    v_lshl_add_u32 v14, v15, 3, v14
    v_lshl_add_u32 v14, v12, 7, v14
    v_add_u32 v22, s29, v14
    s_mov_b32 s52, s40
    s_and_b32 s53, s41, 0xffff
    s_mov_b32 s54, 13631488
    s_mov_b32 s55, 0x20000
    s_mov_b32 s60, s34
    s_and_b32 s61, s35, 0xffff
    s_mov_b32 s62, 1605632
    s_mov_b32 s63, 0x20000
    s_waitcnt vmcnt(0)
    v_lshlrev_b32 v128, 16, v96
    v_and_b32 v129, 0xffff0000, v96
    v_lshlrev_b32 v130, 16, v97
    v_and_b32 v131, 0xffff0000, v97
    v_lshlrev_b32 v132, 16, v98
    v_and_b32 v133, 0xffff0000, v98
    v_lshlrev_b32 v134, 16, v99
    v_and_b32 v135, 0xffff0000, v99
    v_lshlrev_b32 v136, 16, v100
    v_and_b32 v137, 0xffff0000, v100
    v_lshlrev_b32 v138, 16, v101
    v_and_b32 v139, 0xffff0000, v101
    v_lshlrev_b32 v140, 16, v102
    v_and_b32 v141, 0xffff0000, v102
    v_lshlrev_b32 v142, 16, v103
    v_and_b32 v143, 0xffff0000, v103
    v_lshlrev_b32 v144, 16, v104
    v_and_b32 v145, 0xffff0000, v104
    v_lshlrev_b32 v146, 16, v105
    v_and_b32 v147, 0xffff0000, v105
    v_lshlrev_b32 v148, 16, v106
    v_and_b32 v149, 0xffff0000, v106
    v_lshlrev_b32 v150, 16, v116
    v_and_b32 v152, 0xffff0000, v116
    v_lshlrev_b32 v154, 16, v117
    v_and_b32 v156, 0xffff0000, v117
    v_lshlrev_b32 v151, 16, v118
    v_and_b32 v153, 0xffff0000, v118
    v_lshlrev_b32 v155, 16, v119
    v_and_b32 v157, 0xffff0000, v119
    v_pk_mul_f32 v[158:159], v[128:129], v[156:157]
    v_pk_fma_f32 v[158:159], v[130:131], v[154:155], v[158:159]
    v_pk_fma_f32 v[158:159], v[132:133], v[152:153], v[158:159]
    v_pk_fma_f32 v[158:159], v[134:135], v[150:151], v[158:159]
    v_cvt_pk_bf16_f32 v159, v158, v159
    v_lshlrev_b32 v174, 16, v107
    v_and_b32 v175, 0xffff0000, v107
    v_lshlrev_b32 v158, 16, v159
    v_and_b32 v159, 0xffff0000, v159
    v_pk_mul_f32 v[158:159], v[158:159], v[174:175]
    v_pk_mul_f32 v[160:161], v[130:131], v[156:157]
    v_pk_fma_f32 v[160:161], v[132:133], v[154:155], v[160:161]
    v_pk_fma_f32 v[160:161], v[134:135], v[152:153], v[160:161]
    v_pk_fma_f32 v[160:161], v[136:137], v[150:151], v[160:161]
    v_cvt_pk_bf16_f32 v161, v160, v161
    v_lshlrev_b32 v174, 16, v108
    v_and_b32 v175, 0xffff0000, v108
    v_lshlrev_b32 v160, 16, v161
    v_and_b32 v161, 0xffff0000, v161
    v_pk_mul_f32 v[160:161], v[160:161], v[174:175]
    v_pk_mul_f32 v[162:163], v[132:133], v[156:157]
    v_pk_fma_f32 v[162:163], v[134:135], v[154:155], v[162:163]
    v_pk_fma_f32 v[162:163], v[136:137], v[152:153], v[162:163]
    v_pk_fma_f32 v[162:163], v[138:139], v[150:151], v[162:163]
    v_cvt_pk_bf16_f32 v163, v162, v163
    v_lshlrev_b32 v174, 16, v109
    v_and_b32 v175, 0xffff0000, v109
    v_lshlrev_b32 v162, 16, v163
    v_and_b32 v163, 0xffff0000, v163
    v_pk_mul_f32 v[162:163], v[162:163], v[174:175]
    v_pk_mul_f32 v[164:165], v[134:135], v[156:157]
    v_pk_fma_f32 v[164:165], v[136:137], v[154:155], v[164:165]
    v_pk_fma_f32 v[164:165], v[138:139], v[152:153], v[164:165]
    v_pk_fma_f32 v[164:165], v[140:141], v[150:151], v[164:165]
    v_cvt_pk_bf16_f32 v165, v164, v165
    v_lshlrev_b32 v174, 16, v110
    v_and_b32 v175, 0xffff0000, v110
    v_lshlrev_b32 v164, 16, v165
    v_and_b32 v165, 0xffff0000, v165
    v_pk_mul_f32 v[164:165], v[164:165], v[174:175]
    v_pk_mul_f32 v[166:167], v[136:137], v[156:157]
    v_pk_fma_f32 v[166:167], v[138:139], v[154:155], v[166:167]
    v_pk_fma_f32 v[166:167], v[140:141], v[152:153], v[166:167]
    v_pk_fma_f32 v[166:167], v[142:143], v[150:151], v[166:167]
    v_cvt_pk_bf16_f32 v167, v166, v167
    v_lshlrev_b32 v174, 16, v111
    v_and_b32 v175, 0xffff0000, v111
    v_lshlrev_b32 v166, 16, v167
    v_and_b32 v167, 0xffff0000, v167
    v_pk_mul_f32 v[166:167], v[166:167], v[174:175]
    v_pk_mul_f32 v[168:169], v[138:139], v[156:157]
    v_pk_fma_f32 v[168:169], v[140:141], v[154:155], v[168:169]
    v_pk_fma_f32 v[168:169], v[142:143], v[152:153], v[168:169]
    v_pk_fma_f32 v[168:169], v[144:145], v[150:151], v[168:169]
    v_cvt_pk_bf16_f32 v169, v168, v169
    v_lshlrev_b32 v174, 16, v112
    v_and_b32 v175, 0xffff0000, v112
    v_lshlrev_b32 v168, 16, v169
    v_and_b32 v169, 0xffff0000, v169
    v_pk_mul_f32 v[168:169], v[168:169], v[174:175]
    v_pk_mul_f32 v[170:171], v[140:141], v[156:157]
    v_pk_fma_f32 v[170:171], v[142:143], v[154:155], v[170:171]
    v_pk_fma_f32 v[170:171], v[144:145], v[152:153], v[170:171]
    v_pk_fma_f32 v[170:171], v[146:147], v[150:151], v[170:171]
    v_cvt_pk_bf16_f32 v171, v170, v171
    v_lshlrev_b32 v174, 16, v113
    v_and_b32 v175, 0xffff0000, v113
    v_lshlrev_b32 v170, 16, v171
    v_and_b32 v171, 0xffff0000, v171
    v_pk_mul_f32 v[170:171], v[170:171], v[174:175]
    v_pk_mul_f32 v[172:173], v[142:143], v[156:157]
    v_pk_fma_f32 v[172:173], v[144:145], v[154:155], v[172:173]
    v_pk_fma_f32 v[172:173], v[146:147], v[152:153], v[172:173]
    v_pk_fma_f32 v[172:173], v[148:149], v[150:151], v[172:173]
    v_cvt_pk_bf16_f32 v173, v172, v173
    v_lshlrev_b32 v174, 16, v114
    v_and_b32 v175, 0xffff0000, v114
    v_lshlrev_b32 v172, 16, v173
    v_and_b32 v173, 0xffff0000, v173
    v_pk_mul_f32 v[172:173], v[172:173], v[174:175]
    v_cvt_pk_bf16_f32 v176, v172, v170
    v_cvt_pk_bf16_f32 v177, v168, v166
    v_cvt_pk_bf16_f32 v178, v164, v162
    v_cvt_pk_bf16_f32 v179, v160, v158
    v_cvt_pk_bf16_f32 v180, v173, v171
    v_cvt_pk_bf16_f32 v181, v169, v167
    v_cvt_pk_bf16_f32 v182, v165, v163
    v_cvt_pk_bf16_f32 v183, v161, v159
    v_lshlrev_b32 v90, 8, v89
    v_lshlrev_b32 v91, 4, v88
    v_sub_u32 v90, v90, v91
    s_lshl_b32 s7, s10, 5
    s_sub_u32 s7, 147568, s7
    v_add_u32 v90, s7, v90
    ds_write_b128 v90, v[176:179]
    ds_write_b128 v90, v[180:183] offset:128
    s_waitcnt lgkmcnt(0)
    s_barrier
    v_add_u32 v10, 0, v7
    v_add_u32 v11, 0, v8
    v_add_u32 v9, 0, v3
    ds_read_b64_tr_b16 v[44:45], v10 offset:0
    ds_read_b64_tr_b16 v[46:47], v10 offset:1024
    ds_read_b128 v[28:31], v9 offset:0
    ds_read_b128 v[32:35], v9 offset:4096
    ds_read_b128 v[36:39], v9 offset:8192
    ds_read_b128 v[40:43], v9 offset:12288
    ds_read_b64_tr_b16 v[48:49], v11 offset:0
    ds_read_b64_tr_b16 v[50:51], v11 offset:1024
    s_waitcnt lgkmcnt(0)
    v_mfma_f32_32x32x16_bf16 v[76:91], v[44:47], v[28:31], 0
    v_add_u32 v9, 0, v4
    ds_read_b64_tr_b16 v[68:69], v10 offset:4096
    ds_read_b64_tr_b16 v[70:71], v10 offset:5120
    v_mfma_f32_32x32x16_bf16 v[92:107], v[44:47], v[32:35], 0
    ds_read_b128 v[52:55], v9 offset:0
    ds_read_b128 v[56:59], v9 offset:4096
    v_mfma_f32_32x32x16_bf16 v[108:123], v[44:47], v[36:39], 0
    ds_read_b128 v[60:63], v9 offset:8192
    ds_read_b128 v[64:67], v9 offset:12288
    v_mfma_f32_32x32x16_bf16 v[124:139], v[44:47], v[40:43], 0
    ds_read_b64_tr_b16 v[72:73], v11 offset:4096
    ds_read_b64_tr_b16 v[74:75], v11 offset:5120
    v_mfma_f32_32x32x16_bf16 v[188:203], v[48:51], v[40:43], 0
    v_mfma_f32_32x32x16_bf16 v[172:187], v[48:51], v[36:39], 0
    v_mfma_f32_32x32x16_bf16 v[156:171], v[48:51], v[32:35], 0
    v_mfma_f32_32x32x16_bf16 v[140:155], v[48:51], v[28:31], 0
    s_waitcnt lgkmcnt(0)
    v_mfma_f32_32x32x16_bf16 v[76:91], v[68:71], v[52:55], v[76:91]
    v_add_u32 v9, 0, v5
    ds_read_b64_tr_b16 v[44:45], v10 offset:8192
    ds_read_b64_tr_b16 v[46:47], v10 offset:9216
    v_mfma_f32_32x32x16_bf16 v[92:107], v[68:71], v[56:59], v[92:107]
    ds_read_b128 v[28:31], v9 offset:0
    ds_read_b128 v[32:35], v9 offset:4096
    v_mfma_f32_32x32x16_bf16 v[108:123], v[68:71], v[60:63], v[108:123]
    ds_read_b128 v[36:39], v9 offset:8192
    ds_read_b128 v[40:43], v9 offset:12288
    v_mfma_f32_32x32x16_bf16 v[124:139], v[68:71], v[64:67], v[124:139]
    ds_read_b64_tr_b16 v[48:49], v11 offset:8192
    ds_read_b64_tr_b16 v[50:51], v11 offset:9216
    v_mfma_f32_32x32x16_bf16 v[188:203], v[72:75], v[64:67], v[188:203]
    v_mfma_f32_32x32x16_bf16 v[172:187], v[72:75], v[60:63], v[172:187]
    v_mfma_f32_32x32x16_bf16 v[156:171], v[72:75], v[56:59], v[156:171]
    v_mfma_f32_32x32x16_bf16 v[140:155], v[72:75], v[52:55], v[140:155]
    s_waitcnt lgkmcnt(0)
    v_mfma_f32_32x32x16_bf16 v[76:91], v[44:47], v[28:31], v[76:91]
    v_add_u32 v9, 0, v6
    ds_read_b64_tr_b16 v[68:69], v10 offset:12288
    ds_read_b64_tr_b16 v[70:71], v10 offset:13312
    v_mfma_f32_32x32x16_bf16 v[92:107], v[44:47], v[32:35], v[92:107]
    ds_read_b128 v[52:55], v9 offset:0
    ds_read_b128 v[56:59], v9 offset:4096
    v_mfma_f32_32x32x16_bf16 v[108:123], v[44:47], v[36:39], v[108:123]
    ds_read_b128 v[60:63], v9 offset:8192
    ds_read_b128 v[64:67], v9 offset:12288
    v_mfma_f32_32x32x16_bf16 v[124:139], v[44:47], v[40:43], v[124:139]
    ds_read_b64_tr_b16 v[72:73], v11 offset:12288
    ds_read_b64_tr_b16 v[74:75], v11 offset:13312
    v_mfma_f32_32x32x16_bf16 v[188:203], v[48:51], v[40:43], v[188:203]
    v_mfma_f32_32x32x16_bf16 v[172:187], v[48:51], v[36:39], v[172:187]
    v_mfma_f32_32x32x16_bf16 v[156:171], v[48:51], v[32:35], v[156:171]
    v_mfma_f32_32x32x16_bf16 v[140:155], v[48:51], v[28:31], v[140:155]
    s_waitcnt lgkmcnt(0)
    s_barrier
    v_mfma_f32_32x32x16_bf16 v[76:91], v[68:71], v[52:55], v[76:91]
    v_add_u32 v10, 49152, v7
    v_add_u32 v11, 49152, v8
    v_add_u32 v9, 49152, v3
    ds_read_b64_tr_b16 v[44:45], v10 offset:0
    ds_read_b64_tr_b16 v[46:47], v10 offset:1024
    v_mov_b32 v12, 155648
    v_mfma_f32_32x32x16_bf16 v[92:107], v[68:71], v[56:59], v[92:107]
    ds_read_b128 v[28:31], v9 offset:0
    ds_read_b128 v[32:35], v9 offset:4096
    ds_read_b32 v23, v12
    v_mfma_f32_32x32x16_bf16 v[108:123], v[68:71], v[60:63], v[108:123]
    ds_read_b128 v[36:39], v9 offset:8192
    ds_read_b128 v[40:43], v9 offset:12288
    v_mfma_f32_32x32x16_bf16 v[124:139], v[68:71], v[64:67], v[124:139]
    ds_read_b64_tr_b16 v[48:49], v11 offset:0
    ds_read_b64_tr_b16 v[50:51], v11 offset:1024
    v_mfma_f32_32x32x16_bf16 v[188:203], v[72:75], v[64:67], v[188:203]
    v_mfma_f32_32x32x16_bf16 v[172:187], v[72:75], v[60:63], v[172:187]
    v_mfma_f32_32x32x16_bf16 v[156:171], v[72:75], v[56:59], v[156:171]
    v_mfma_f32_32x32x16_bf16 v[140:155], v[72:75], v[52:55], v[140:155]
    s_waitcnt lgkmcnt(0)
    v_mfma_f32_32x32x16_bf16 v[76:91], v[44:47], v[28:31], v[76:91]
    v_add_u32 v9, 49152, v4
    ds_read_b64_tr_b16 v[68:69], v10 offset:4096
    ds_read_b64_tr_b16 v[70:71], v10 offset:5120
    v_mfma_f32_32x32x16_bf16 v[92:107], v[44:47], v[32:35], v[92:107]
    ds_read_b128 v[52:55], v9 offset:0
    ds_read_b128 v[56:59], v9 offset:4096
    v_mfma_f32_32x32x16_bf16 v[108:123], v[44:47], v[36:39], v[108:123]
    ds_read_b128 v[60:63], v9 offset:8192
    ds_read_b128 v[64:67], v9 offset:12288
    v_mfma_f32_32x32x16_bf16 v[124:139], v[44:47], v[40:43], v[124:139]
    ds_read_b64_tr_b16 v[72:73], v11 offset:4096
    ds_read_b64_tr_b16 v[74:75], v11 offset:5120
    v_mfma_f32_32x32x16_bf16 v[188:203], v[48:51], v[40:43], v[188:203]
    v_mfma_f32_32x32x16_bf16 v[172:187], v[48:51], v[36:39], v[172:187]
    v_mfma_f32_32x32x16_bf16 v[156:171], v[48:51], v[32:35], v[156:171]
    v_mfma_f32_32x32x16_bf16 v[140:155], v[48:51], v[28:31], v[140:155]
    s_waitcnt lgkmcnt(0)
    v_mfma_f32_32x32x16_bf16 v[76:91], v[68:71], v[52:55], v[76:91]
    v_add_u32 v9, 49152, v5
    ds_read_b64_tr_b16 v[44:45], v10 offset:8192
    ds_read_b64_tr_b16 v[46:47], v10 offset:9216
    v_mfma_f32_32x32x16_bf16 v[92:107], v[68:71], v[56:59], v[92:107]
    ds_read_b128 v[28:31], v9 offset:0
    ds_read_b128 v[32:35], v9 offset:4096
    v_mfma_f32_32x32x16_bf16 v[108:123], v[68:71], v[60:63], v[108:123]
    ds_read_b128 v[36:39], v9 offset:8192
    ds_read_b128 v[40:43], v9 offset:12288
    v_mfma_f32_32x32x16_bf16 v[124:139], v[68:71], v[64:67], v[124:139]
    ds_read_b64_tr_b16 v[48:49], v11 offset:8192
    ds_read_b64_tr_b16 v[50:51], v11 offset:9216
    v_mfma_f32_32x32x16_bf16 v[188:203], v[72:75], v[64:67], v[188:203]
    v_mfma_f32_32x32x16_bf16 v[172:187], v[72:75], v[60:63], v[172:187]
    v_mfma_f32_32x32x16_bf16 v[156:171], v[72:75], v[56:59], v[156:171]
    v_mfma_f32_32x32x16_bf16 v[140:155], v[72:75], v[52:55], v[140:155]
    s_waitcnt lgkmcnt(0)
    v_mfma_f32_32x32x16_bf16 v[76:91], v[44:47], v[28:31], v[76:91]
    v_add_u32 v9, 49152, v6
    ds_read_b64_tr_b16 v[68:69], v10 offset:12288
    ds_read_b64_tr_b16 v[70:71], v10 offset:13312
    v_mfma_f32_32x32x16_bf16 v[92:107], v[44:47], v[32:35], v[92:107]
    ds_read_b128 v[52:55], v9 offset:0
    ds_read_b128 v[56:59], v9 offset:4096
    v_mfma_f32_32x32x16_bf16 v[108:123], v[44:47], v[36:39], v[108:123]
    ds_read_b128 v[60:63], v9 offset:8192
    ds_read_b128 v[64:67], v9 offset:12288
    v_mfma_f32_32x32x16_bf16 v[124:139], v[44:47], v[40:43], v[124:139]
    ds_read_b64_tr_b16 v[72:73], v11 offset:12288
    ds_read_b64_tr_b16 v[74:75], v11 offset:13312
    v_mfma_f32_32x32x16_bf16 v[188:203], v[48:51], v[40:43], v[188:203]
    v_mfma_f32_32x32x16_bf16 v[172:187], v[48:51], v[36:39], v[172:187]
    v_mfma_f32_32x32x16_bf16 v[156:171], v[48:51], v[32:35], v[156:171]
    v_mfma_f32_32x32x16_bf16 v[140:155], v[48:51], v[28:31], v[140:155]
    s_waitcnt lgkmcnt(0)
    s_barrier
    v_mfma_f32_32x32x16_bf16 v[76:91], v[68:71], v[52:55], v[76:91]
    v_add_u32 v10, 98304, v7
    v_add_u32 v11, 98304, v8
    v_add_u32 v9, 98304, v3
    ds_read_b64_tr_b16 v[44:45], v10 offset:0
    ds_read_b64_tr_b16 v[46:47], v10 offset:1024
    v_mfma_f32_32x32x16_bf16 v[92:107], v[68:71], v[56:59], v[92:107]
    ds_read_b128 v[28:31], v9 offset:0
    ds_read_b128 v[32:35], v9 offset:4096
    v_mfma_f32_32x32x16_bf16 v[108:123], v[68:71], v[60:63], v[108:123]
    ds_read_b128 v[36:39], v9 offset:8192
    ds_read_b128 v[40:43], v9 offset:12288
    v_mfma_f32_32x32x16_bf16 v[124:139], v[68:71], v[64:67], v[124:139]
    ds_read_b64_tr_b16 v[48:49], v11 offset:0
    ds_read_b64_tr_b16 v[50:51], v11 offset:1024
    v_mfma_f32_32x32x16_bf16 v[188:203], v[72:75], v[64:67], v[188:203]
    v_mfma_f32_32x32x16_bf16 v[172:187], v[72:75], v[60:63], v[172:187]
    v_mfma_f32_32x32x16_bf16 v[156:171], v[72:75], v[56:59], v[156:171]
    v_mfma_f32_32x32x16_bf16 v[140:155], v[72:75], v[52:55], v[140:155]
    s_waitcnt lgkmcnt(0)
    v_mfma_f32_32x32x16_bf16 v[76:91], v[44:47], v[28:31], v[76:91]
    v_add_u32 v9, 98304, v4
    ds_read_b64_tr_b16 v[68:69], v10 offset:4096
    ds_read_b64_tr_b16 v[70:71], v10 offset:5120
    v_mfma_f32_32x32x16_bf16 v[92:107], v[44:47], v[32:35], v[92:107]
    ds_read_b128 v[52:55], v9 offset:0
    ds_read_b128 v[56:59], v9 offset:4096
    v_mfma_f32_32x32x16_bf16 v[108:123], v[44:47], v[36:39], v[108:123]
    ds_read_b128 v[60:63], v9 offset:8192
    ds_read_b128 v[64:67], v9 offset:12288
    v_mfma_f32_32x32x16_bf16 v[124:139], v[44:47], v[40:43], v[124:139]
    ds_read_b64_tr_b16 v[72:73], v11 offset:4096
    ds_read_b64_tr_b16 v[74:75], v11 offset:5120
    v_mfma_f32_32x32x16_bf16 v[188:203], v[48:51], v[40:43], v[188:203]
    v_mfma_f32_32x32x16_bf16 v[172:187], v[48:51], v[36:39], v[172:187]
    v_mfma_f32_32x32x16_bf16 v[156:171], v[48:51], v[32:35], v[156:171]
    v_mfma_f32_32x32x16_bf16 v[140:155], v[48:51], v[28:31], v[140:155]
    s_waitcnt lgkmcnt(0)
    v_mfma_f32_32x32x16_bf16 v[76:91], v[68:71], v[52:55], v[76:91]
    v_add_u32 v9, 98304, v5
    ds_read_b64_tr_b16 v[44:45], v10 offset:8192
    ds_read_b64_tr_b16 v[46:47], v10 offset:9216
    v_mfma_f32_32x32x16_bf16 v[92:107], v[68:71], v[56:59], v[92:107]
    ds_read_b128 v[28:31], v9 offset:0
    ds_read_b128 v[32:35], v9 offset:4096
    v_mfma_f32_32x32x16_bf16 v[108:123], v[68:71], v[60:63], v[108:123]
    ds_read_b128 v[36:39], v9 offset:8192
    ds_read_b128 v[40:43], v9 offset:12288
    v_mfma_f32_32x32x16_bf16 v[124:139], v[68:71], v[64:67], v[124:139]
    ds_read_b64_tr_b16 v[48:49], v11 offset:8192
    ds_read_b64_tr_b16 v[50:51], v11 offset:9216
    v_mfma_f32_32x32x16_bf16 v[188:203], v[72:75], v[64:67], v[188:203]
    v_mfma_f32_32x32x16_bf16 v[172:187], v[72:75], v[60:63], v[172:187]
    v_mfma_f32_32x32x16_bf16 v[156:171], v[72:75], v[56:59], v[156:171]
    v_mfma_f32_32x32x16_bf16 v[140:155], v[72:75], v[52:55], v[140:155]
    s_waitcnt lgkmcnt(0)
    v_mfma_f32_32x32x16_bf16 v[76:91], v[44:47], v[28:31], v[76:91]
    v_add_u32 v9, 98304, v6
    ds_read_b64_tr_b16 v[68:69], v10 offset:12288
    ds_read_b64_tr_b16 v[70:71], v10 offset:13312
    v_mfma_f32_32x32x16_bf16 v[92:107], v[44:47], v[32:35], v[92:107]
    ds_read_b128 v[52:55], v9 offset:0
    ds_read_b128 v[56:59], v9 offset:4096
    v_mfma_f32_32x32x16_bf16 v[108:123], v[44:47], v[36:39], v[108:123]
    ds_read_b128 v[60:63], v9 offset:8192
    ds_read_b128 v[64:67], v9 offset:12288
    v_mfma_f32_32x32x16_bf16 v[124:139], v[44:47], v[40:43], v[124:139]
    ds_read_b64_tr_b16 v[72:73], v11 offset:12288
    ds_read_b64_tr_b16 v[74:75], v11 offset:13312
    v_mfma_f32_32x32x16_bf16 v[188:203], v[48:51], v[40:43], v[188:203]
    v_mfma_f32_32x32x16_bf16 v[172:187], v[48:51], v[36:39], v[172:187]
    v_mfma_f32_32x32x16_bf16 v[156:171], v[48:51], v[32:35], v[156:171]
    v_mfma_f32_32x32x16_bf16 v[140:155], v[48:51], v[28:31], v[140:155]
    s_waitcnt lgkmcnt(0)
    s_barrier
    v_mfma_f32_32x32x16_bf16 v[76:91], v[68:71], v[52:55], v[76:91]
    v_add_u32 v10, 0, v7
    v_add_u32 v11, 0, v8
    v_add_u32 v9, 0, v3
    ds_read_b64_tr_b16 v[44:45], v10 offset:0
    ds_read_b64_tr_b16 v[46:47], v10 offset:1024
    s_mov_b32 s28, 172032
    v_mfma_f32_32x32x16_bf16 v[92:107], v[68:71], v[56:59], v[92:107]
    ds_read_b128 v[28:31], v9 offset:0
    ds_read_b128 v[32:35], v9 offset:4096
    s_add_u32 m0, s29, 147456
    s_nop 0
    buffer_load_dwordx4 v0, s[60:63], s28 offen lds
    v_mfma_f32_32x32x16_bf16 v[108:123], v[68:71], v[60:63], v[108:123]
    ds_read_b128 v[36:39], v9 offset:8192
    ds_read_b128 v[40:43], v9 offset:12288
    s_mov_b32 s28, 179200
    v_mfma_f32_32x32x16_bf16 v[124:139], v[68:71], v[64:67], v[124:139]
    ds_read_b64_tr_b16 v[48:49], v11 offset:0
    ds_read_b64_tr_b16 v[50:51], v11 offset:1024
    s_add_u32 m0, s29, 148480
    s_nop 0
    buffer_load_dwordx4 v0, s[60:63], s28 offen lds
    v_mfma_f32_32x32x16_bf16 v[188:203], v[72:75], v[64:67], v[188:203]
    s_mov_b32 s28, 186368
    v_mfma_f32_32x32x16_bf16 v[172:187], v[72:75], v[60:63], v[172:187]
    s_add_u32 m0, s29, 149504
    s_nop 0
    buffer_load_dwordx4 v0, s[60:63], s28 offen lds
    v_mfma_f32_32x32x16_bf16 v[156:171], v[72:75], v[56:59], v[156:171]
    s_mov_b32 s28, 193536
    v_mfma_f32_32x32x16_bf16 v[140:155], v[72:75], v[52:55], v[140:155]
    s_add_u32 m0, s29, 150528
    s_nop 0
    buffer_load_dwordx4 v0, s[60:63], s28 offen lds
    s_waitcnt lgkmcnt(0)
    v_mfma_f32_32x32x16_bf16 v[76:91], v[44:47], v[28:31], v[76:91]
    v_add_u32 v9, 0, v4
    ds_read_b64_tr_b16 v[68:69], v10 offset:4096
    ds_read_b64_tr_b16 v[70:71], v10 offset:5120
    v_mfma_f32_32x32x16_bf16 v[92:107], v[44:47], v[32:35], v[92:107]
    ds_read_b128 v[52:55], v9 offset:0
    ds_read_b128 v[56:59], v9 offset:4096
    v_mfma_f32_32x32x16_bf16 v[108:123], v[44:47], v[36:39], v[108:123]
    ds_read_b128 v[60:63], v9 offset:8192
    ds_read_b128 v[64:67], v9 offset:12288
    v_mfma_f32_32x32x16_bf16 v[124:139], v[44:47], v[40:43], v[124:139]
    ds_read_b64_tr_b16 v[72:73], v11 offset:4096
    ds_read_b64_tr_b16 v[74:75], v11 offset:5120
    v_mfma_f32_32x32x16_bf16 v[188:203], v[48:51], v[40:43], v[188:203]
    v_mfma_f32_32x32x16_bf16 v[172:187], v[48:51], v[36:39], v[172:187]
    v_mfma_f32_32x32x16_bf16 v[156:171], v[48:51], v[32:35], v[156:171]
    v_mfma_f32_32x32x16_bf16 v[140:155], v[48:51], v[28:31], v[140:155]
    s_waitcnt lgkmcnt(0)
    v_mfma_f32_32x32x16_bf16 v[76:91], v[68:71], v[52:55], v[76:91]
    v_add_u32 v9, 0, v5
    ds_read_b64_tr_b16 v[44:45], v10 offset:8192
    ds_read_b64_tr_b16 v[46:47], v10 offset:9216
    v_mfma_f32_32x32x16_bf16 v[92:107], v[68:71], v[56:59], v[92:107]
    ds_read_b128 v[28:31], v9 offset:0
    ds_read_b128 v[32:35], v9 offset:4096
    v_mfma_f32_32x32x16_bf16 v[108:123], v[68:71], v[60:63], v[108:123]
    ds_read_b128 v[36:39], v9 offset:8192
    ds_read_b128 v[40:43], v9 offset:12288
    v_mfma_f32_32x32x16_bf16 v[124:139], v[68:71], v[64:67], v[124:139]
    ds_read_b64_tr_b16 v[48:49], v11 offset:8192
    ds_read_b64_tr_b16 v[50:51], v11 offset:9216
    v_mfma_f32_32x32x16_bf16 v[188:203], v[72:75], v[64:67], v[188:203]
    v_mfma_f32_32x32x16_bf16 v[172:187], v[72:75], v[60:63], v[172:187]
    v_mfma_f32_32x32x16_bf16 v[156:171], v[72:75], v[56:59], v[156:171]
    v_mfma_f32_32x32x16_bf16 v[140:155], v[72:75], v[52:55], v[140:155]
    s_waitcnt lgkmcnt(0)
    v_mfma_f32_32x32x16_bf16 v[76:91], v[44:47], v[28:31], v[76:91]
    v_add_u32 v9, 0, v6
    ds_read_b64_tr_b16 v[68:69], v10 offset:12288
    ds_read_b64_tr_b16 v[70:71], v10 offset:13312
    v_mfma_f32_32x32x16_bf16 v[92:107], v[44:47], v[32:35], v[92:107]
    ds_read_b128 v[52:55], v9 offset:0
    ds_read_b128 v[56:59], v9 offset:4096
    v_mfma_f32_32x32x16_bf16 v[108:123], v[44:47], v[36:39], v[108:123]
    ds_read_b128 v[60:63], v9 offset:8192
    ds_read_b128 v[64:67], v9 offset:12288
    v_mfma_f32_32x32x16_bf16 v[124:139], v[44:47], v[40:43], v[124:139]
    ds_read_b64_tr_b16 v[72:73], v11 offset:12288
    ds_read_b64_tr_b16 v[74:75], v11 offset:13312
    v_mfma_f32_32x32x16_bf16 v[188:203], v[48:51], v[40:43], v[188:203]
    v_mfma_f32_32x32x16_bf16 v[172:187], v[48:51], v[36:39], v[172:187]
    v_mfma_f32_32x32x16_bf16 v[156:171], v[48:51], v[32:35], v[156:171]
    v_mfma_f32_32x32x16_bf16 v[140:155], v[48:51], v[28:31], v[140:155]
    s_waitcnt lgkmcnt(0)
    s_barrier
    v_mfma_f32_32x32x16_bf16 v[76:91], v[68:71], v[52:55], v[76:91]
    v_add_u32 v10, 49152, v7
    v_add_u32 v11, 49152, v8
    v_add_u32 v9, 49152, v3
    ds_read_b64_tr_b16 v[44:45], v10 offset:0
    ds_read_b64_tr_b16 v[46:47], v10 offset:1024
    v_mfma_f32_32x32x16_bf16 v[92:107], v[68:71], v[56:59], v[92:107]
    ds_read_b128 v[28:31], v9 offset:0
    ds_read_b128 v[32:35], v9 offset:4096
    v_mfma_f32_32x32x16_bf16 v[108:123], v[68:71], v[60:63], v[108:123]
    ds_read_b128 v[36:39], v9 offset:8192
    ds_read_b128 v[40:43], v9 offset:12288
    v_mfma_f32_32x32x16_bf16 v[124:139], v[68:71], v[64:67], v[124:139]
    ds_read_b64_tr_b16 v[48:49], v11 offset:0
    ds_read_b64_tr_b16 v[50:51], v11 offset:1024
    v_mfma_f32_32x32x16_bf16 v[188:203], v[72:75], v[64:67], v[188:203]
    v_mfma_f32_32x32x16_bf16 v[172:187], v[72:75], v[60:63], v[172:187]
    v_mfma_f32_32x32x16_bf16 v[156:171], v[72:75], v[56:59], v[156:171]
    v_mfma_f32_32x32x16_bf16 v[140:155], v[72:75], v[52:55], v[140:155]
    s_waitcnt lgkmcnt(0)
    v_mfma_f32_32x32x16_bf16 v[76:91], v[44:47], v[28:31], v[76:91]
    v_add_u32 v9, 49152, v4
    ds_read_b64_tr_b16 v[68:69], v10 offset:4096
    ds_read_b64_tr_b16 v[70:71], v10 offset:5120
    v_mfma_f32_32x32x16_bf16 v[92:107], v[44:47], v[32:35], v[92:107]
    ds_read_b128 v[52:55], v9 offset:0
    ds_read_b128 v[56:59], v9 offset:4096
    v_mfma_f32_32x32x16_bf16 v[108:123], v[44:47], v[36:39], v[108:123]
    ds_read_b128 v[60:63], v9 offset:8192
    ds_read_b128 v[64:67], v9 offset:12288
    v_mfma_f32_32x32x16_bf16 v[124:139], v[44:47], v[40:43], v[124:139]
    ds_read_b64_tr_b16 v[72:73], v11 offset:4096
    ds_read_b64_tr_b16 v[74:75], v11 offset:5120
    v_mfma_f32_32x32x16_bf16 v[188:203], v[48:51], v[40:43], v[188:203]
    v_mfma_f32_32x32x16_bf16 v[172:187], v[48:51], v[36:39], v[172:187]
    v_mfma_f32_32x32x16_bf16 v[156:171], v[48:51], v[32:35], v[156:171]
    v_mfma_f32_32x32x16_bf16 v[140:155], v[48:51], v[28:31], v[140:155]
    s_waitcnt lgkmcnt(0)
    v_mfma_f32_32x32x16_bf16 v[76:91], v[68:71], v[52:55], v[76:91]
    v_add_u32 v9, 49152, v5
    ds_read_b64_tr_b16 v[44:45], v10 offset:8192
    ds_read_b64_tr_b16 v[46:47], v10 offset:9216
    v_mfma_f32_32x32x16_bf16 v[92:107], v[68:71], v[56:59], v[92:107]
    ds_read_b128 v[28:31], v9 offset:0
    ds_read_b128 v[32:35], v9 offset:4096
    v_mfma_f32_32x32x16_bf16 v[108:123], v[68:71], v[60:63], v[108:123]
    ds_read_b128 v[36:39], v9 offset:8192
    ds_read_b128 v[40:43], v9 offset:12288
    v_mfma_f32_32x32x16_bf16 v[124:139], v[68:71], v[64:67], v[124:139]
    ds_read_b64_tr_b16 v[48:49], v11 offset:8192
    ds_read_b64_tr_b16 v[50:51], v11 offset:9216
    v_mfma_f32_32x32x16_bf16 v[188:203], v[72:75], v[64:67], v[188:203]
    v_mfma_f32_32x32x16_bf16 v[172:187], v[72:75], v[60:63], v[172:187]
    v_mfma_f32_32x32x16_bf16 v[156:171], v[72:75], v[56:59], v[156:171]
    v_mfma_f32_32x32x16_bf16 v[140:155], v[72:75], v[52:55], v[140:155]
    s_waitcnt lgkmcnt(0)
    v_mfma_f32_32x32x16_bf16 v[76:91], v[44:47], v[28:31], v[76:91]
    v_add_u32 v9, 49152, v6
    ds_read_b64_tr_b16 v[68:69], v10 offset:12288
    ds_read_b64_tr_b16 v[70:71], v10 offset:13312
    v_mfma_f32_32x32x16_bf16 v[92:107], v[44:47], v[32:35], v[92:107]
    ds_read_b128 v[52:55], v9 offset:0
    ds_read_b128 v[56:59], v9 offset:4096
    v_mfma_f32_32x32x16_bf16 v[108:123], v[44:47], v[36:39], v[108:123]
    ds_read_b128 v[60:63], v9 offset:8192
    ds_read_b128 v[64:67], v9 offset:12288
    v_mfma_f32_32x32x16_bf16 v[124:139], v[44:47], v[40:43], v[124:139]
    ds_read_b64_tr_b16 v[72:73], v11 offset:12288
    ds_read_b64_tr_b16 v[74:75], v11 offset:13312
    v_mfma_f32_32x32x16_bf16 v[188:203], v[48:51], v[40:43], v[188:203]
    v_mfma_f32_32x32x16_bf16 v[172:187], v[48:51], v[36:39], v[172:187]
    v_mfma_f32_32x32x16_bf16 v[156:171], v[48:51], v[32:35], v[156:171]
    v_mfma_f32_32x32x16_bf16 v[140:155], v[48:51], v[28:31], v[140:155]
    s_waitcnt lgkmcnt(0)
    s_barrier
    v_mfma_f32_32x32x16_bf16 v[76:91], v[68:71], v[52:55], v[76:91]
    v_add_u32 v10, 98304, v7
    v_add_u32 v11, 98304, v8
    v_add_u32 v9, 98304, v3
    ds_read_b64_tr_b16 v[44:45], v10 offset:0
    ds_read_b64_tr_b16 v[46:47], v10 offset:1024
    s_mov_b32 s28, 0
    s_add_u32 m0, s29, 49152
    s_nop 0
    buffer_load_dwordx4 v0, s[60:63], s28 offen lds
    v_mfma_f32_32x32x16_bf16 v[92:107], v[68:71], v[56:59], v[92:107]
    ds_read_b128 v[28:31], v9 offset:0
    ds_read_b128 v[32:35], v9 offset:4096
    s_mov_b32 s28, 7168
    s_add_u32 m0, s29, 50176
    s_nop 0
    buffer_load_dwordx4 v0, s[60:63], s28 offen lds
    v_mfma_f32_32x32x16_bf16 v[108:123], v[68:71], v[60:63], v[108:123]
    ds_read_b128 v[36:39], v9 offset:8192
    ds_read_b128 v[40:43], v9 offset:12288
    s_mov_b32 s28, 14336
    s_add_u32 m0, s29, 51200
    s_nop 0
    buffer_load_dwordx4 v0, s[60:63], s28 offen lds
    v_mfma_f32_32x32x16_bf16 v[124:139], v[68:71], v[64:67], v[124:139]
    ds_read_b64_tr_b16 v[48:49], v11 offset:0
    ds_read_b64_tr_b16 v[50:51], v11 offset:1024
    s_mov_b32 s28, 21504
    s_add_u32 m0, s29, 52224
    s_nop 0
    buffer_load_dwordx4 v0, s[60:63], s28 offen lds
    v_mfma_f32_32x32x16_bf16 v[188:203], v[72:75], v[64:67], v[188:203]
    s_mov_b32 s28, 28672
    s_add_u32 m0, s29, 65536
    s_nop 0
    buffer_load_dwordx4 v0, s[60:63], s28 offen lds
    v_mfma_f32_32x32x16_bf16 v[172:187], v[72:75], v[60:63], v[172:187]
    s_mov_b32 s28, 35840
    s_add_u32 m0, s29, 66560
    s_nop 0
    buffer_load_dwordx4 v0, s[60:63], s28 offen lds
    v_mfma_f32_32x32x16_bf16 v[156:171], v[72:75], v[56:59], v[156:171]
    s_mov_b32 s28, 43008
    s_add_u32 m0, s29, 67584
    s_nop 0
    buffer_load_dwordx4 v0, s[60:63], s28 offen lds
    v_mfma_f32_32x32x16_bf16 v[140:155], v[72:75], v[52:55], v[140:155]
    s_mov_b32 s28, 50176
    s_waitcnt lgkmcnt(0)
    v_mfma_f32_32x32x16_bf16 v[76:91], v[44:47], v[28:31], v[76:91]
    v_add_u32 v9, 98304, v4
    ds_read_b64_tr_b16 v[68:69], v10 offset:4096
    ds_read_b64_tr_b16 v[70:71], v10 offset:5120
    s_add_u32 m0, s29, 68608
    s_nop 0
    buffer_load_dwordx4 v0, s[60:63], s28 offen lds
    v_mfma_f32_32x32x16_bf16 v[92:107], v[44:47], v[32:35], v[92:107]
    ds_read_b128 v[52:55], v9 offset:0
    ds_read_b128 v[56:59], v9 offset:4096
    s_mov_b32 s28, 57344
    v_mfma_f32_32x32x16_bf16 v[108:123], v[44:47], v[36:39], v[108:123]
    ds_read_b128 v[60:63], v9 offset:8192
    ds_read_b128 v[64:67], v9 offset:12288
    s_add_u32 m0, s29, 81920
    s_nop 0
    buffer_load_dwordx4 v0, s[60:63], s28 offen lds
    v_mfma_f32_32x32x16_bf16 v[124:139], v[44:47], v[40:43], v[124:139]
    ds_read_b64_tr_b16 v[72:73], v11 offset:4096
    ds_read_b64_tr_b16 v[74:75], v11 offset:5120
    s_mov_b32 s28, 64512
    v_mfma_f32_32x32x16_bf16 v[188:203], v[48:51], v[40:43], v[188:203]
    s_add_u32 m0, s29, 82944
    s_nop 0
    buffer_load_dwordx4 v0, s[60:63], s28 offen lds
    v_mfma_f32_32x32x16_bf16 v[172:187], v[48:51], v[36:39], v[172:187]
    s_mov_b32 s28, 71680
    v_mfma_f32_32x32x16_bf16 v[156:171], v[48:51], v[32:35], v[156:171]
    s_add_u32 m0, s29, 83968
    s_nop 0
    buffer_load_dwordx4 v0, s[60:63], s28 offen lds
    v_mfma_f32_32x32x16_bf16 v[140:155], v[48:51], v[28:31], v[140:155]
    s_mov_b32 s28, 78848
    s_waitcnt lgkmcnt(0)
    v_mfma_f32_32x32x16_bf16 v[76:91], v[68:71], v[52:55], v[76:91]
    v_add_u32 v9, 98304, v5
    ds_read_b64_tr_b16 v[44:45], v10 offset:8192
    ds_read_b64_tr_b16 v[46:47], v10 offset:9216
    s_add_u32 m0, s29, 84992
    s_nop 0
    buffer_load_dwordx4 v0, s[60:63], s28 offen lds
    v_mfma_f32_32x32x16_bf16 v[92:107], v[68:71], v[56:59], v[92:107]
    ds_read_b128 v[28:31], v9 offset:0
    ds_read_b128 v[32:35], v9 offset:4096
    v_mfma_f32_32x32x16_bf16 v[108:123], v[68:71], v[60:63], v[108:123]
    ds_read_b128 v[36:39], v9 offset:8192
    ds_read_b128 v[40:43], v9 offset:12288
    v_mfma_f32_32x32x16_bf16 v[124:139], v[68:71], v[64:67], v[124:139]
    ds_read_b64_tr_b16 v[48:49], v11 offset:8192
    ds_read_b64_tr_b16 v[50:51], v11 offset:9216
    v_mfma_f32_32x32x16_bf16 v[188:203], v[72:75], v[64:67], v[188:203]
    v_mfma_f32_32x32x16_bf16 v[172:187], v[72:75], v[60:63], v[172:187]
    v_mfma_f32_32x32x16_bf16 v[156:171], v[72:75], v[56:59], v[156:171]
    v_mfma_f32_32x32x16_bf16 v[140:155], v[72:75], v[52:55], v[140:155]
    s_waitcnt lgkmcnt(0)
    v_mfma_f32_32x32x16_bf16 v[76:91], v[44:47], v[28:31], v[76:91]
    v_add_u32 v9, 98304, v6
    ds_read_b64_tr_b16 v[68:69], v10 offset:12288
    ds_read_b64_tr_b16 v[70:71], v10 offset:13312
    v_mfma_f32_32x32x16_bf16 v[92:107], v[44:47], v[32:35], v[92:107]
    ds_read_b128 v[52:55], v9 offset:0
    ds_read_b128 v[56:59], v9 offset:4096
    v_mfma_f32_32x32x16_bf16 v[108:123], v[44:47], v[36:39], v[108:123]
    ds_read_b128 v[60:63], v9 offset:8192
    ds_read_b128 v[64:67], v9 offset:12288
    v_mfma_f32_32x32x16_bf16 v[124:139], v[44:47], v[40:43], v[124:139]
    ds_read_b64_tr_b16 v[72:73], v11 offset:12288
    ds_read_b64_tr_b16 v[74:75], v11 offset:13312
    v_mfma_f32_32x32x16_bf16 v[188:203], v[48:51], v[40:43], v[188:203]
    v_mfma_f32_32x32x16_bf16 v[172:187], v[48:51], v[36:39], v[172:187]
    v_mfma_f32_32x32x16_bf16 v[156:171], v[48:51], v[32:35], v[156:171]
    v_mfma_f32_32x32x16_bf16 v[140:155], v[48:51], v[28:31], v[140:155]
    s_waitcnt lgkmcnt(0)
    s_barrier
    v_mfma_f32_32x32x16_bf16 v[76:91], v[68:71], v[52:55], v[76:91]
    v_add_u32 v10, 0, v7
    v_add_u32 v11, 0, v8
    v_add_u32 v9, 0, v3
    ds_read_b64_tr_b16 v[44:45], v10 offset:0
    ds_read_b64_tr_b16 v[46:47], v10 offset:1024
    buffer_load_dwordx2 v[236:237], v24, s[52:55], 0 offen offset:0 sc1
    buffer_load_dwordx2 v[238:239], v24, s[52:55], 0 offen offset:256 sc1
    v_mfma_f32_32x32x16_bf16 v[92:107], v[68:71], v[56:59], v[92:107]
    ds_read_b128 v[28:31], v9 offset:0
    ds_read_b128 v[32:35], v9 offset:4096
    buffer_load_dwordx2 v[240:241], v24, s[52:55], 0 offen offset:512 sc1
    buffer_load_dwordx2 v[242:243], v24, s[52:55], 0 offen offset:768 sc1
    v_mfma_f32_32x32x16_bf16 v[108:123], v[68:71], v[60:63], v[108:123]
    ds_read_b128 v[36:39], v9 offset:8192
    ds_read_b128 v[40:43], v9 offset:12288
    buffer_load_dwordx4 v[204:207], v25, s[52:55], 0 offen offset:0 sc1
    buffer_load_dwordx4 v[208:211], v25, s[52:55], 0 offen offset:32 sc1
    v_mfma_f32_32x32x16_bf16 v[124:139], v[68:71], v[64:67], v[124:139]
    ds_read_b64_tr_b16 v[48:49], v11 offset:0
    ds_read_b64_tr_b16 v[50:51], v11 offset:1024
    buffer_load_dwordx4 v[212:215], v25, s[52:55], 0 offen offset:64 sc1
    buffer_load_dwordx4 v[216:219], v25, s[52:55], 0 offen offset:96 sc1
    v_mfma_f32_32x32x16_bf16 v[188:203], v[72:75], v[64:67], v[188:203]
    buffer_load_dwordx4 v[220:223], v25, s[52:55], 0 offen offset:128 sc1
    buffer_load_dwordx4 v[224:227], v25, s[52:55], 0 offen offset:160 sc1
    v_mfma_f32_32x32x16_bf16 v[172:187], v[72:75], v[60:63], v[172:187]
    buffer_load_dwordx4 v[228:231], v25, s[52:55], 0 offen offset:192 sc1
    buffer_load_dwordx4 v[232:235], v25, s[52:55], 0 offen offset:224 sc1
    v_mfma_f32_32x32x16_bf16 v[156:171], v[72:75], v[56:59], v[156:171]
    s_mov_b32 s28, 86016
    s_add_u32 m0, s29, 98304
    s_nop 0
    buffer_load_dwordx4 v0, s[60:63], s28 offen lds
    v_mfma_f32_32x32x16_bf16 v[140:155], v[72:75], v[52:55], v[140:155]
    s_mov_b32 s28, 93184
    s_add_u32 m0, s29, 99328
    s_nop 0
    buffer_load_dwordx4 v0, s[60:63], s28 offen lds
    s_waitcnt lgkmcnt(0)
    v_mfma_f32_32x32x16_bf16 v[76:91], v[44:47], v[28:31], v[76:91]
    v_add_u32 v9, 0, v4
    ds_read_b64_tr_b16 v[68:69], v10 offset:4096
    ds_read_b64_tr_b16 v[70:71], v10 offset:5120
    s_mov_b32 s28, 100352
    s_add_u32 m0, s29, 100352
    s_nop 0
    buffer_load_dwordx4 v0, s[60:63], s28 offen lds
    v_mfma_f32_32x32x16_bf16 v[92:107], v[44:47], v[32:35], v[92:107]
    ds_read_b128 v[52:55], v9 offset:0
    ds_read_b128 v[56:59], v9 offset:4096
    s_mov_b32 s28, 107520
    s_add_u32 m0, s29, 101376
    s_nop 0
    buffer_load_dwordx4 v0, s[60:63], s28 offen lds
    v_mfma_f32_32x32x16_bf16 v[108:123], v[44:47], v[36:39], v[108:123]
    ds_read_b128 v[60:63], v9 offset:8192
    ds_read_b128 v[64:67], v9 offset:12288
    s_mov_b32 s28, 114688
    s_add_u32 m0, s29, 114688
    s_nop 0
    buffer_load_dwordx4 v0, s[60:63], s28 offen lds
    v_mfma_f32_32x32x16_bf16 v[124:139], v[44:47], v[40:43], v[124:139]
    ds_read_b64_tr_b16 v[72:73], v11 offset:4096
    ds_read_b64_tr_b16 v[74:75], v11 offset:5120
    s_mov_b32 s28, 121856
    s_add_u32 m0, s29, 115712
    s_nop 0
    buffer_load_dwordx4 v0, s[60:63], s28 offen lds
    v_mfma_f32_32x32x16_bf16 v[188:203], v[48:51], v[40:43], v[188:203]
    s_mov_b32 s28, 129024
    s_add_u32 m0, s29, 116736
    s_nop 0
    buffer_load_dwordx4 v0, s[60:63], s28 offen lds
    v_mfma_f32_32x32x16_bf16 v[172:187], v[48:51], v[36:39], v[172:187]
    s_mov_b32 s28, 136192
    s_add_u32 m0, s29, 117760
    s_nop 0
    buffer_load_dwordx4 v0, s[60:63], s28 offen lds
    v_mfma_f32_32x32x16_bf16 v[156:171], v[48:51], v[32:35], v[156:171]
    s_mov_b32 s28, 143360
    s_add_u32 m0, s29, 131072
    s_nop 0
    buffer_load_dwordx4 v0, s[60:63], s28 offen lds
    v_mfma_f32_32x32x16_bf16 v[140:155], v[48:51], v[28:31], v[140:155]
    s_mov_b32 s28, 150528
    s_waitcnt lgkmcnt(0)
    v_mfma_f32_32x32x16_bf16 v[76:91], v[68:71], v[52:55], v[76:91]
    v_add_u32 v9, 0, v5
    ds_read_b64_tr_b16 v[44:45], v10 offset:8192
    ds_read_b64_tr_b16 v[46:47], v10 offset:9216
    s_add_u32 m0, s29, 132096
    s_nop 0
    buffer_load_dwordx4 v0, s[60:63], s28 offen lds
    v_mfma_f32_32x32x16_bf16 v[92:107], v[68:71], v[56:59], v[92:107]
    ds_read_b128 v[28:31], v9 offset:0
    ds_read_b128 v[32:35], v9 offset:4096
    s_mov_b32 s28, 157696
    v_mfma_f32_32x32x16_bf16 v[108:123], v[68:71], v[60:63], v[108:123]
    ds_read_b128 v[36:39], v9 offset:8192
    ds_read_b128 v[40:43], v9 offset:12288
    s_add_u32 m0, s29, 133120
    s_nop 0
    buffer_load_dwordx4 v0, s[60:63], s28 offen lds
    v_mfma_f32_32x32x16_bf16 v[124:139], v[68:71], v[64:67], v[124:139]
    ds_read_b64_tr_b16 v[48:49], v11 offset:8192
    ds_read_b64_tr_b16 v[50:51], v11 offset:9216
    s_mov_b32 s28, 164864
    v_mfma_f32_32x32x16_bf16 v[188:203], v[72:75], v[64:67], v[188:203]
    s_add_u32 m0, s29, 134144
    s_nop 0
    buffer_load_dwordx4 v0, s[60:63], s28 offen lds
    v_mfma_f32_32x32x16_bf16 v[172:187], v[72:75], v[60:63], v[172:187]
    v_mfma_f32_32x32x16_bf16 v[156:171], v[72:75], v[56:59], v[156:171]
    v_mfma_f32_32x32x16_bf16 v[140:155], v[72:75], v[52:55], v[140:155]
    s_waitcnt lgkmcnt(0)
    v_mfma_f32_32x32x16_bf16 v[76:91], v[44:47], v[28:31], v[76:91]
    v_add_u32 v9, 0, v6
    ds_read_b64_tr_b16 v[68:69], v10 offset:12288
    ds_read_b64_tr_b16 v[70:71], v10 offset:13312
    v_mfma_f32_32x32x16_bf16 v[92:107], v[44:47], v[32:35], v[92:107]
    ds_read_b128 v[52:55], v9 offset:0
    ds_read_b128 v[56:59], v9 offset:4096
    v_mfma_f32_32x32x16_bf16 v[108:123], v[44:47], v[36:39], v[108:123]
    ds_read_b128 v[60:63], v9 offset:8192
    ds_read_b128 v[64:67], v9 offset:12288
    v_mfma_f32_32x32x16_bf16 v[124:139], v[44:47], v[40:43], v[124:139]
    ds_read_b64_tr_b16 v[72:73], v11 offset:12288
    ds_read_b64_tr_b16 v[74:75], v11 offset:13312
    v_mfma_f32_32x32x16_bf16 v[188:203], v[48:51], v[40:43], v[188:203]
    v_mfma_f32_32x32x16_bf16 v[172:187], v[48:51], v[36:39], v[172:187]
    v_mfma_f32_32x32x16_bf16 v[156:171], v[48:51], v[32:35], v[156:171]
    v_mfma_f32_32x32x16_bf16 v[140:155], v[48:51], v[28:31], v[140:155]
    s_waitcnt lgkmcnt(0)
    s_barrier
    v_mfma_f32_32x32x16_bf16 v[76:91], v[68:71], v[52:55], v[76:91]
    v_mfma_f32_32x32x16_bf16 v[92:107], v[68:71], v[56:59], v[92:107]
    v_mfma_f32_32x32x16_bf16 v[108:123], v[68:71], v[60:63], v[108:123]
    v_mfma_f32_32x32x16_bf16 v[124:139], v[68:71], v[64:67], v[124:139]
    v_mfma_f32_32x32x16_bf16 v[188:203], v[72:75], v[64:67], v[188:203]
    v_mfma_f32_32x32x16_bf16 v[172:187], v[72:75], v[60:63], v[172:187]
    v_mfma_f32_32x32x16_bf16 v[156:171], v[72:75], v[56:59], v[156:171]
    v_mfma_f32_32x32x16_bf16 v[140:155], v[72:75], v[52:55], v[140:155]
    s_waitcnt vmcnt(12)
    v_mul_f32 v60, v237, v237
    v_mul_f32 v62, v239, v239
    v_mul_f32 v64, v241, v241
    v_mul_f32 v66, v243, v243
    s_mov_b32 s13, 131072
    s_mov_b32 s14, 262144
    s_mov_b32 s15, 393216
    s_nop 4
    v_pk_fma_f32 v[76:77], v[236:237], v[204:205], v[76:77] op_sel_hi:[0,1,1] neg_lo:[1,0,0] neg_hi:[1,0,0]
    v_pk_fma_f32 v[78:79], v[236:237], v[206:207], v[78:79] op_sel_hi:[0,1,1] neg_lo:[1,0,0] neg_hi:[1,0,0]
    v_pk_fma_f32 v[80:81], v[236:237], v[208:209], v[80:81] op_sel_hi:[0,1,1] neg_lo:[1,0,0] neg_hi:[1,0,0]
    v_pk_fma_f32 v[82:83], v[236:237], v[210:211], v[82:83] op_sel_hi:[0,1,1] neg_lo:[1,0,0] neg_hi:[1,0,0]
    v_pk_fma_f32 v[84:85], v[236:237], v[212:213], v[84:85] op_sel_hi:[0,1,1] neg_lo:[1,0,0] neg_hi:[1,0,0]
    v_pk_fma_f32 v[86:87], v[236:237], v[214:215], v[86:87] op_sel_hi:[0,1,1] neg_lo:[1,0,0] neg_hi:[1,0,0]
    v_pk_fma_f32 v[88:89], v[236:237], v[216:217], v[88:89] op_sel_hi:[0,1,1] neg_lo:[1,0,0] neg_hi:[1,0,0]
    v_pk_fma_f32 v[90:91], v[236:237], v[218:219], v[90:91] op_sel_hi:[0,1,1] neg_lo:[1,0,0] neg_hi:[1,0,0]
    v_max_f32 v76, 0, v76
    v_max_f32 v77, 0, v77
    v_max_f32 v78, 0, v78
    v_max_f32 v79, 0, v79
    v_max_f32 v80, 0, v80
    v_max_f32 v81, 0, v81
    v_max_f32 v82, 0, v82
    v_max_f32 v83, 0, v83
    v_pk_mul_f32 v[84:85], v[84:85], v[60:61] op_sel_hi:[1,0]
    v_pk_mul_f32 v[86:87], v[86:87], v[60:61] op_sel_hi:[1,0]
    v_pk_mul_f32 v[88:89], v[88:89], v[60:61] op_sel_hi:[1,0]
    v_pk_mul_f32 v[90:91], v[90:91], v[60:61] op_sel_hi:[1,0]
    v_pk_mul_f32 v[76:77], v[76:77], v[84:85]
    v_pk_mul_f32 v[78:79], v[78:79], v[86:87]
    v_pk_mul_f32 v[80:81], v[80:81], v[88:89]
    v_pk_mul_f32 v[82:83], v[82:83], v[90:91]
    v_cvt_pk_bf16_f32 v28, v76, v77
    v_cvt_pk_bf16_f32 v29, v78, v79
    v_cvt_pk_bf16_f32 v30, v80, v81
    v_cvt_pk_bf16_f32 v31, v82, v83
    buffer_store_dwordx4 v[28:31], v26, s[52:55], 0 offen offset:0 sc1
    v_pk_fma_f32 v[140:141], v[236:237], v[220:221], v[140:141] op_sel_hi:[0,1,1] neg_lo:[1,0,0] neg_hi:[1,0,0]
    v_pk_fma_f32 v[142:143], v[236:237], v[222:223], v[142:143] op_sel_hi:[0,1,1] neg_lo:[1,0,0] neg_hi:[1,0,0]
    v_pk_fma_f32 v[144:145], v[236:237], v[224:225], v[144:145] op_sel_hi:[0,1,1] neg_lo:[1,0,0] neg_hi:[1,0,0]
    v_pk_fma_f32 v[146:147], v[236:237], v[226:227], v[146:147] op_sel_hi:[0,1,1] neg_lo:[1,0,0] neg_hi:[1,0,0]
    v_pk_fma_f32 v[148:149], v[236:237], v[228:229], v[148:149] op_sel_hi:[0,1,1] neg_lo:[1,0,0] neg_hi:[1,0,0]
    v_pk_fma_f32 v[150:151], v[236:237], v[230:231], v[150:151] op_sel_hi:[0,1,1] neg_lo:[1,0,0] neg_hi:[1,0,0]
    v_pk_fma_f32 v[152:153], v[236:237], v[232:233], v[152:153] op_sel_hi:[0,1,1] neg_lo:[1,0,0] neg_hi:[1,0,0]
    v_pk_fma_f32 v[154:155], v[236:237], v[234:235], v[154:155] op_sel_hi:[0,1,1] neg_lo:[1,0,0] neg_hi:[1,0,0]
    v_max_f32 v140, 0, v140
    v_max_f32 v141, 0, v141
    v_max_f32 v142, 0, v142
    v_max_f32 v143, 0, v143
    v_max_f32 v144, 0, v144
    v_max_f32 v145, 0, v145
    v_max_f32 v146, 0, v146
    v_max_f32 v147, 0, v147
    v_pk_mul_f32 v[148:149], v[148:149], v[60:61] op_sel_hi:[1,0]
    v_pk_mul_f32 v[150:151], v[150:151], v[60:61] op_sel_hi:[1,0]
    v_pk_mul_f32 v[152:153], v[152:153], v[60:61] op_sel_hi:[1,0]
    v_pk_mul_f32 v[154:155], v[154:155], v[60:61] op_sel_hi:[1,0]
    v_pk_mul_f32 v[140:141], v[140:141], v[148:149]
    v_pk_mul_f32 v[142:143], v[142:143], v[150:151]
    v_pk_mul_f32 v[144:145], v[144:145], v[152:153]
    v_pk_mul_f32 v[146:147], v[146:147], v[154:155]
    v_cvt_pk_bf16_f32 v32, v140, v141
    v_cvt_pk_bf16_f32 v33, v142, v143
    v_cvt_pk_bf16_f32 v34, v144, v145
    v_cvt_pk_bf16_f32 v35, v146, v147
    buffer_store_dwordx4 v[32:35], v26, s[52:55], 0 offen offset:1024 sc1
    v_pk_fma_f32 v[92:93], v[238:239], v[204:205], v[92:93] op_sel_hi:[0,1,1] neg_lo:[1,0,0] neg_hi:[1,0,0]
    v_pk_fma_f32 v[94:95], v[238:239], v[206:207], v[94:95] op_sel_hi:[0,1,1] neg_lo:[1,0,0] neg_hi:[1,0,0]
    v_pk_fma_f32 v[96:97], v[238:239], v[208:209], v[96:97] op_sel_hi:[0,1,1] neg_lo:[1,0,0] neg_hi:[1,0,0]
    v_pk_fma_f32 v[98:99], v[238:239], v[210:211], v[98:99] op_sel_hi:[0,1,1] neg_lo:[1,0,0] neg_hi:[1,0,0]
    v_pk_fma_f32 v[100:101], v[238:239], v[212:213], v[100:101] op_sel_hi:[0,1,1] neg_lo:[1,0,0] neg_hi:[1,0,0]
    v_pk_fma_f32 v[102:103], v[238:239], v[214:215], v[102:103] op_sel_hi:[0,1,1] neg_lo:[1,0,0] neg_hi:[1,0,0]
    v_pk_fma_f32 v[104:105], v[238:239], v[216:217], v[104:105] op_sel_hi:[0,1,1] neg_lo:[1,0,0] neg_hi:[1,0,0]
    v_pk_fma_f32 v[106:107], v[238:239], v[218:219], v[106:107] op_sel_hi:[0,1,1] neg_lo:[1,0,0] neg_hi:[1,0,0]
    v_max_f32 v92, 0, v92
    v_max_f32 v93, 0, v93
    v_max_f32 v94, 0, v94
    v_max_f32 v95, 0, v95
    v_max_f32 v96, 0, v96
    v_max_f32 v97, 0, v97
    v_max_f32 v98, 0, v98
    v_max_f32 v99, 0, v99
    v_pk_mul_f32 v[100:101], v[100:101], v[62:63] op_sel_hi:[1,0]
    v_pk_mul_f32 v[102:103], v[102:103], v[62:63] op_sel_hi:[1,0]
    v_pk_mul_f32 v[104:105], v[104:105], v[62:63] op_sel_hi:[1,0]
    v_pk_mul_f32 v[106:107], v[106:107], v[62:63] op_sel_hi:[1,0]
    v_pk_mul_f32 v[92:93], v[92:93], v[100:101]
    v_pk_mul_f32 v[94:95], v[94:95], v[102:103]
    v_pk_mul_f32 v[96:97], v[96:97], v[104:105]
    v_pk_mul_f32 v[98:99], v[98:99], v[106:107]
    v_cvt_pk_bf16_f32 v36, v92, v93
    v_cvt_pk_bf16_f32 v37, v94, v95
    v_cvt_pk_bf16_f32 v38, v96, v97
    v_cvt_pk_bf16_f32 v39, v98, v99
    buffer_store_dwordx4 v[36:39], v26, s[52:55], s13 offen offset:0 sc1
    v_pk_fma_f32 v[156:157], v[238:239], v[220:221], v[156:157] op_sel_hi:[0,1,1] neg_lo:[1,0,0] neg_hi:[1,0,0]
    v_pk_fma_f32 v[158:159], v[238:239], v[222:223], v[158:159] op_sel_hi:[0,1,1] neg_lo:[1,0,0] neg_hi:[1,0,0]
    v_pk_fma_f32 v[160:161], v[238:239], v[224:225], v[160:161] op_sel_hi:[0,1,1] neg_lo:[1,0,0] neg_hi:[1,0,0]
    v_pk_fma_f32 v[162:163], v[238:239], v[226:227], v[162:163] op_sel_hi:[0,1,1] neg_lo:[1,0,0] neg_hi:[1,0,0]
    v_pk_fma_f32 v[164:165], v[238:239], v[228:229], v[164:165] op_sel_hi:[0,1,1] neg_lo:[1,0,0] neg_hi:[1,0,0]
    v_pk_fma_f32 v[166:167], v[238:239], v[230:231], v[166:167] op_sel_hi:[0,1,1] neg_lo:[1,0,0] neg_hi:[1,0,0]
    v_pk_fma_f32 v[168:169], v[238:239], v[232:233], v[168:169] op_sel_hi:[0,1,1] neg_lo:[1,0,0] neg_hi:[1,0,0]
    v_pk_fma_f32 v[170:171], v[238:239], v[234:235], v[170:171] op_sel_hi:[0,1,1] neg_lo:[1,0,0] neg_hi:[1,0,0]
    v_max_f32 v156, 0, v156
    v_max_f32 v157, 0, v157
    v_max_f32 v158, 0, v158
    v_max_f32 v159, 0, v159
    v_max_f32 v160, 0, v160
    v_max_f32 v161, 0, v161
    v_max_f32 v162, 0, v162
    v_max_f32 v163, 0, v163
    v_pk_mul_f32 v[164:165], v[164:165], v[62:63] op_sel_hi:[1,0]
    v_pk_mul_f32 v[166:167], v[166:167], v[62:63] op_sel_hi:[1,0]
    v_pk_mul_f32 v[168:169], v[168:169], v[62:63] op_sel_hi:[1,0]
    v_pk_mul_f32 v[170:171], v[170:171], v[62:63] op_sel_hi:[1,0]
    v_pk_mul_f32 v[156:157], v[156:157], v[164:165]
    v_pk_mul_f32 v[158:159], v[158:159], v[166:167]
    v_pk_mul_f32 v[160:161], v[160:161], v[168:169]
    v_pk_mul_f32 v[162:163], v[162:163], v[170:171]
    v_cvt_pk_bf16_f32 v40, v156, v157
    v_cvt_pk_bf16_f32 v41, v158, v159
    v_cvt_pk_bf16_f32 v42, v160, v161
    v_cvt_pk_bf16_f32 v43, v162, v163
    buffer_store_dwordx4 v[40:43], v26, s[52:55], s13 offen offset:1024 sc1
    v_pk_fma_f32 v[108:109], v[240:241], v[204:205], v[108:109] op_sel_hi:[0,1,1] neg_lo:[1,0,0] neg_hi:[1,0,0]
    v_pk_fma_f32 v[110:111], v[240:241], v[206:207], v[110:111] op_sel_hi:[0,1,1] neg_lo:[1,0,0] neg_hi:[1,0,0]
    v_pk_fma_f32 v[112:113], v[240:241], v[208:209], v[112:113] op_sel_hi:[0,1,1] neg_lo:[1,0,0] neg_hi:[1,0,0]
    v_pk_fma_f32 v[114:115], v[240:241], v[210:211], v[114:115] op_sel_hi:[0,1,1] neg_lo:[1,0,0] neg_hi:[1,0,0]
    v_pk_fma_f32 v[116:117], v[240:241], v[212:213], v[116:117] op_sel_hi:[0,1,1] neg_lo:[1,0,0] neg_hi:[1,0,0]
    v_pk_fma_f32 v[118:119], v[240:241], v[214:215], v[118:119] op_sel_hi:[0,1,1] neg_lo:[1,0,0] neg_hi:[1,0,0]
    v_pk_fma_f32 v[120:121], v[240:241], v[216:217], v[120:121] op_sel_hi:[0,1,1] neg_lo:[1,0,0] neg_hi:[1,0,0]
    v_pk_fma_f32 v[122:123], v[240:241], v[218:219], v[122:123] op_sel_hi:[0,1,1] neg_lo:[1,0,0] neg_hi:[1,0,0]
    v_max_f32 v108, 0, v108
    v_max_f32 v109, 0, v109
    v_max_f32 v110, 0, v110
    v_max_f32 v111, 0, v111
    v_max_f32 v112, 0, v112
    v_max_f32 v113, 0, v113
    v_max_f32 v114, 0, v114
    v_max_f32 v115, 0, v115
    v_pk_mul_f32 v[116:117], v[116:117], v[64:65] op_sel_hi:[1,0]
    v_pk_mul_f32 v[118:119], v[118:119], v[64:65] op_sel_hi:[1,0]
    v_pk_mul_f32 v[120:121], v[120:121], v[64:65] op_sel_hi:[1,0]
    v_pk_mul_f32 v[122:123], v[122:123], v[64:65] op_sel_hi:[1,0]
    v_pk_mul_f32 v[108:109], v[108:109], v[116:117]
    v_pk_mul_f32 v[110:111], v[110:111], v[118:119]
    v_pk_mul_f32 v[112:113], v[112:113], v[120:121]
    v_pk_mul_f32 v[114:115], v[114:115], v[122:123]
    v_cvt_pk_bf16_f32 v44, v108, v109
    v_cvt_pk_bf16_f32 v45, v110, v111
    v_cvt_pk_bf16_f32 v46, v112, v113
    v_cvt_pk_bf16_f32 v47, v114, v115
    buffer_store_dwordx4 v[44:47], v26, s[52:55], s14 offen offset:0 sc1
    v_pk_fma_f32 v[172:173], v[240:241], v[220:221], v[172:173] op_sel_hi:[0,1,1] neg_lo:[1,0,0] neg_hi:[1,0,0]
    v_pk_fma_f32 v[174:175], v[240:241], v[222:223], v[174:175] op_sel_hi:[0,1,1] neg_lo:[1,0,0] neg_hi:[1,0,0]
    v_pk_fma_f32 v[176:177], v[240:241], v[224:225], v[176:177] op_sel_hi:[0,1,1] neg_lo:[1,0,0] neg_hi:[1,0,0]
    v_pk_fma_f32 v[178:179], v[240:241], v[226:227], v[178:179] op_sel_hi:[0,1,1] neg_lo:[1,0,0] neg_hi:[1,0,0]
    v_pk_fma_f32 v[180:181], v[240:241], v[228:229], v[180:181] op_sel_hi:[0,1,1] neg_lo:[1,0,0] neg_hi:[1,0,0]
    v_pk_fma_f32 v[182:183], v[240:241], v[230:231], v[182:183] op_sel_hi:[0,1,1] neg_lo:[1,0,0] neg_hi:[1,0,0]
    v_pk_fma_f32 v[184:185], v[240:241], v[232:233], v[184:185] op_sel_hi:[0,1,1] neg_lo:[1,0,0] neg_hi:[1,0,0]
    v_pk_fma_f32 v[186:187], v[240:241], v[234:235], v[186:187] op_sel_hi:[0,1,1] neg_lo:[1,0,0] neg_hi:[1,0,0]
    v_max_f32 v172, 0, v172
    v_max_f32 v173, 0, v173
    v_max_f32 v174, 0, v174
    v_max_f32 v175, 0, v175
    v_max_f32 v176, 0, v176
    v_max_f32 v177, 0, v177
    v_max_f32 v178, 0, v178
    v_max_f32 v179, 0, v179
    v_pk_mul_f32 v[180:181], v[180:181], v[64:65] op_sel_hi:[1,0]
    v_pk_mul_f32 v[182:183], v[182:183], v[64:65] op_sel_hi:[1,0]
    v_pk_mul_f32 v[184:185], v[184:185], v[64:65] op_sel_hi:[1,0]
    v_pk_mul_f32 v[186:187], v[186:187], v[64:65] op_sel_hi:[1,0]
    v_pk_mul_f32 v[172:173], v[172:173], v[180:181]
    v_pk_mul_f32 v[174:175], v[174:175], v[182:183]
    v_pk_mul_f32 v[176:177], v[176:177], v[184:185]
    v_pk_mul_f32 v[178:179], v[178:179], v[186:187]
    v_cvt_pk_bf16_f32 v48, v172, v173
    v_cvt_pk_bf16_f32 v49, v174, v175
    v_cvt_pk_bf16_f32 v50, v176, v177
    v_cvt_pk_bf16_f32 v51, v178, v179
    buffer_store_dwordx4 v[48:51], v26, s[52:55], s14 offen offset:1024 sc1
    v_pk_fma_f32 v[124:125], v[242:243], v[204:205], v[124:125] op_sel_hi:[0,1,1] neg_lo:[1,0,0] neg_hi:[1,0,0]
    v_pk_fma_f32 v[126:127], v[242:243], v[206:207], v[126:127] op_sel_hi:[0,1,1] neg_lo:[1,0,0] neg_hi:[1,0,0]
    v_pk_fma_f32 v[128:129], v[242:243], v[208:209], v[128:129] op_sel_hi:[0,1,1] neg_lo:[1,0,0] neg_hi:[1,0,0]
    v_pk_fma_f32 v[130:131], v[242:243], v[210:211], v[130:131] op_sel_hi:[0,1,1] neg_lo:[1,0,0] neg_hi:[1,0,0]
    v_pk_fma_f32 v[132:133], v[242:243], v[212:213], v[132:133] op_sel_hi:[0,1,1] neg_lo:[1,0,0] neg_hi:[1,0,0]
    v_pk_fma_f32 v[134:135], v[242:243], v[214:215], v[134:135] op_sel_hi:[0,1,1] neg_lo:[1,0,0] neg_hi:[1,0,0]
    v_pk_fma_f32 v[136:137], v[242:243], v[216:217], v[136:137] op_sel_hi:[0,1,1] neg_lo:[1,0,0] neg_hi:[1,0,0]
    v_pk_fma_f32 v[138:139], v[242:243], v[218:219], v[138:139] op_sel_hi:[0,1,1] neg_lo:[1,0,0] neg_hi:[1,0,0]
    v_max_f32 v124, 0, v124
    v_max_f32 v125, 0, v125
    v_max_f32 v126, 0, v126
    v_max_f32 v127, 0, v127
    v_max_f32 v128, 0, v128
    v_max_f32 v129, 0, v129
    v_max_f32 v130, 0, v130
    v_max_f32 v131, 0, v131
    v_pk_mul_f32 v[132:133], v[132:133], v[66:67] op_sel_hi:[1,0]
    v_pk_mul_f32 v[134:135], v[134:135], v[66:67] op_sel_hi:[1,0]
    v_pk_mul_f32 v[136:137], v[136:137], v[66:67] op_sel_hi:[1,0]
    v_pk_mul_f32 v[138:139], v[138:139], v[66:67] op_sel_hi:[1,0]
    v_pk_mul_f32 v[124:125], v[124:125], v[132:133]
    v_pk_mul_f32 v[126:127], v[126:127], v[134:135]
    v_pk_mul_f32 v[128:129], v[128:129], v[136:137]
    v_pk_mul_f32 v[130:131], v[130:131], v[138:139]
    v_cvt_pk_bf16_f32 v52, v124, v125
    v_cvt_pk_bf16_f32 v53, v126, v127
    v_cvt_pk_bf16_f32 v54, v128, v129
    v_cvt_pk_bf16_f32 v55, v130, v131
    buffer_store_dwordx4 v[52:55], v26, s[52:55], s15 offen offset:0 sc1
    v_pk_fma_f32 v[188:189], v[242:243], v[220:221], v[188:189] op_sel_hi:[0,1,1] neg_lo:[1,0,0] neg_hi:[1,0,0]
    v_pk_fma_f32 v[190:191], v[242:243], v[222:223], v[190:191] op_sel_hi:[0,1,1] neg_lo:[1,0,0] neg_hi:[1,0,0]
    v_pk_fma_f32 v[192:193], v[242:243], v[224:225], v[192:193] op_sel_hi:[0,1,1] neg_lo:[1,0,0] neg_hi:[1,0,0]
    v_pk_fma_f32 v[194:195], v[242:243], v[226:227], v[194:195] op_sel_hi:[0,1,1] neg_lo:[1,0,0] neg_hi:[1,0,0]
    v_pk_fma_f32 v[196:197], v[242:243], v[228:229], v[196:197] op_sel_hi:[0,1,1] neg_lo:[1,0,0] neg_hi:[1,0,0]
    v_pk_fma_f32 v[198:199], v[242:243], v[230:231], v[198:199] op_sel_hi:[0,1,1] neg_lo:[1,0,0] neg_hi:[1,0,0]
    v_pk_fma_f32 v[200:201], v[242:243], v[232:233], v[200:201] op_sel_hi:[0,1,1] neg_lo:[1,0,0] neg_hi:[1,0,0]
    v_pk_fma_f32 v[202:203], v[242:243], v[234:235], v[202:203] op_sel_hi:[0,1,1] neg_lo:[1,0,0] neg_hi:[1,0,0]
    v_max_f32 v188, 0, v188
    v_max_f32 v189, 0, v189
    v_max_f32 v190, 0, v190
    v_max_f32 v191, 0, v191
    v_max_f32 v192, 0, v192
    v_max_f32 v193, 0, v193
    v_max_f32 v194, 0, v194
    v_max_f32 v195, 0, v195
    v_pk_mul_f32 v[196:197], v[196:197], v[66:67] op_sel_hi:[1,0]
    v_pk_mul_f32 v[198:199], v[198:199], v[66:67] op_sel_hi:[1,0]
    v_pk_mul_f32 v[200:201], v[200:201], v[66:67] op_sel_hi:[1,0]
    v_pk_mul_f32 v[202:203], v[202:203], v[66:67] op_sel_hi:[1,0]
    v_pk_mul_f32 v[188:189], v[188:189], v[196:197]
    v_pk_mul_f32 v[190:191], v[190:191], v[198:199]
    v_pk_mul_f32 v[192:193], v[192:193], v[200:201]
    v_pk_mul_f32 v[194:195], v[194:195], v[202:203]
    v_cvt_pk_bf16_f32 v56, v188, v189
    v_cvt_pk_bf16_f32 v57, v190, v191
    v_cvt_pk_bf16_f32 v58, v192, v193
    v_cvt_pk_bf16_f32 v59, v194, v195
    buffer_store_dwordx4 v[56:59], v26, s[52:55], s15 offen offset:1024 sc1
    v_add_u32 v5, 131072, v19
    v_mov_b32 v7, v19
    v_mov_b32 v8, v22
    v_mov_b32 v9, v23
    s_lshr_b32 s7, s18, 1
    s_mul_i32 s7, s7, 56
    s_mul_i32 s8, s10, 14
    s_add_u32 s7, s7, s8
    s_lshl_b32 s7, s7, 7
    s_add_u32 s7, s7, 12845056
    v_min_u32 v6, 13, v2
    v_lshl_add_u32 v6, v6, 7, s7
    v_add_u32 v3, 49152, v8
    v_xor_b32 v4, 64, v3
    ds_read_b64_tr_b16 v[176:177], v3 offset:0
    ds_read_b64_tr_b16 v[178:179], v3 offset:1024
    ds_read_b64_tr_b16 v[180:181], v4 offset:0
    ds_read_b64_tr_b16 v[182:183], v4 offset:1024
    ds_read_b64_tr_b16 v[184:185], v3 offset:2048
    ds_read_b64_tr_b16 v[186:187], v3 offset:3072
    ds_read_b64_tr_b16 v[188:189], v4 offset:2048
    ds_read_b64_tr_b16 v[190:191], v4 offset:3072
    v_add_u32 v3, 65536, v8
    v_xor_b32 v4, 64, v3
    ds_read_b64_tr_b16 v[160:161], v3 offset:0
    ds_read_b64_tr_b16 v[162:163], v3 offset:1024
    ds_read_b64_tr_b16 v[164:165], v4 offset:0
    ds_read_b64_tr_b16 v[166:167], v4 offset:1024
    ds_read_b64_tr_b16 v[168:169], v3 offset:2048
    ds_read_b64_tr_b16 v[170:171], v3 offset:3072
    ds_read_b64_tr_b16 v[172:173], v4 offset:2048
    ds_read_b64_tr_b16 v[174:175], v4 offset:3072
    v_add_u32 v3, 81920, v8
    v_xor_b32 v4, 64, v3
    ds_read_b64_tr_b16 v[144:145], v3 offset:0
    ds_read_b64_tr_b16 v[146:147], v3 offset:1024
    ds_read_b64_tr_b16 v[148:149], v4 offset:0
    ds_read_b64_tr_b16 v[150:151], v4 offset:1024
    ds_read_b64_tr_b16 v[152:153], v3 offset:2048
    ds_read_b64_tr_b16 v[154:155], v3 offset:3072
    ds_read_b64_tr_b16 v[156:157], v4 offset:2048
    ds_read_b64_tr_b16 v[158:159], v4 offset:3072
    s_waitcnt vmcnt(16)
    v_add_u32 v3, 98304, v8
    v_xor_b32 v4, 64, v3
    ds_read_b64_tr_b16 v[128:129], v3 offset:0
    ds_read_b64_tr_b16 v[130:131], v3 offset:1024
    ds_read_b64_tr_b16 v[132:133], v4 offset:0
    ds_read_b64_tr_b16 v[134:135], v4 offset:1024
    ds_read_b64_tr_b16 v[136:137], v3 offset:2048
    ds_read_b64_tr_b16 v[138:139], v3 offset:3072
    ds_read_b64_tr_b16 v[140:141], v4 offset:2048
    ds_read_b64_tr_b16 v[142:143], v4 offset:3072
    s_waitcnt vmcnt(12)
    v_add_u32 v3, 114688, v8
    v_xor_b32 v4, 64, v3
    ds_read_b64_tr_b16 v[112:113], v3 offset:0
    ds_read_b64_tr_b16 v[114:115], v3 offset:1024
    ds_read_b64_tr_b16 v[116:117], v4 offset:0
    ds_read_b64_tr_b16 v[118:119], v4 offset:1024
    ds_read_b64_tr_b16 v[120:121], v3 offset:2048
    ds_read_b64_tr_b16 v[122:123], v3 offset:3072
    ds_read_b64_tr_b16 v[124:125], v4 offset:2048
    ds_read_b64_tr_b16 v[126:127], v4 offset:3072
    s_waitcnt vmcnt(8)
    v_add_u32 v3, 131072, v8
    v_xor_b32 v4, 64, v3
    ds_read_b64_tr_b16 v[96:97], v3 offset:0
    ds_read_b64_tr_b16 v[98:99], v3 offset:1024
    ds_read_b64_tr_b16 v[100:101], v4 offset:0
    ds_read_b64_tr_b16 v[102:103], v4 offset:1024
    ds_read_b64_tr_b16 v[104:105], v3 offset:2048
    ds_read_b64_tr_b16 v[106:107], v3 offset:3072
    ds_read_b64_tr_b16 v[108:109], v4 offset:2048
    ds_read_b64_tr_b16 v[110:111], v4 offset:3072
    s_waitcnt lgkmcnt(0)
    s_waitcnt vmcnt(0)
    s_mov_b64 exec, 1
    buffer_store_dword v23, v20, s[52:55], s6 offen sc1
    s_mov_b64 exec, -1
    s_mov_b32 s28, 200704
    s_add_u32 m0, s29, 49152
    s_nop 0
    buffer_load_dwordx4 v0, s[60:63], s28 offen lds
    s_mov_b32 s28, 207872
    s_add_u32 m0, s29, 50176
    s_nop 0
    buffer_load_dwordx4 v0, s[60:63], s28 offen lds
    s_mov_b32 s28, 215040
    s_add_u32 m0, s29, 51200
    s_nop 0
    buffer_load_dwordx4 v0, s[60:63], s28 offen lds
    s_mov_b32 s28, 222208
    s_add_u32 m0, s29, 52224
    s_nop 0
    buffer_load_dwordx4 v0, s[60:63], s28 offen lds
    s_mov_b32 s28, 229376
    s_add_u32 m0, s29, 65536
    s_nop 0
    buffer_load_dwordx4 v0, s[60:63], s28 offen lds
    s_mov_b32 s28, 236544
    s_add_u32 m0, s29, 66560
    s_nop 0
    buffer_load_dwordx4 v0, s[60:63], s28 offen lds
    s_mov_b32 s28, 243712
    s_add_u32 m0, s29, 67584
    s_nop 0
    buffer_load_dwordx4 v0, s[60:63], s28 offen lds
    s_mov_b32 s28, 250880
    s_add_u32 m0, s29, 68608
    s_nop 0
    buffer_load_dwordx4 v0, s[60:63], s28 offen lds
    s_mov_b32 s28, 258048
    s_add_u32 m0, s29, 81920
    s_nop 0
    buffer_load_dwordx4 v0, s[60:63], s28 offen lds
    s_mov_b32 s28, 265216
    s_add_u32 m0, s29, 82944
    s_nop 0
    buffer_load_dwordx4 v0, s[60:63], s28 offen lds
    s_mov_b32 s28, 272384
    s_add_u32 m0, s29, 83968
    s_nop 0
    buffer_load_dwordx4 v0, s[60:63], s28 offen lds
    s_mov_b32 s28, 279552
    s_add_u32 m0, s29, 84992
    s_nop 0
    buffer_load_dwordx4 v0, s[60:63], s28 offen lds
    s_mov_b32 s28, 286720
    s_add_u32 m0, s29, 98304
    s_nop 0
    buffer_load_dwordx4 v0, s[60:63], s28 offen lds
    s_mov_b32 s28, 293888
    s_add_u32 m0, s29, 99328
    s_nop 0
    buffer_load_dwordx4 v0, s[60:63], s28 offen lds
    s_mov_b32 s28, 301056
    s_add_u32 m0, s29, 100352
    s_nop 0
    buffer_load_dwordx4 v0, s[60:63], s28 offen lds
    s_mov_b32 s28, 308224
    s_add_u32 m0, s29, 101376
    s_nop 0
    buffer_load_dwordx4 v0, s[60:63], s28 offen lds
    s_mov_b32 s28, 315392
    s_add_u32 m0, s29, 114688
    s_nop 0
    buffer_load_dwordx4 v0, s[60:63], s28 offen lds
    s_mov_b32 s28, 322560
    s_add_u32 m0, s29, 115712
    s_nop 0
    buffer_load_dwordx4 v0, s[60:63], s28 offen lds
    s_mov_b32 s28, 329728
    s_add_u32 m0, s29, 116736
    s_nop 0
    buffer_load_dwordx4 v0, s[60:63], s28 offen lds
    s_mov_b32 s28, 336896
    s_add_u32 m0, s29, 117760
    s_nop 0
    buffer_load_dwordx4 v0, s[60:63], s28 offen lds
    s_mov_b32 s28, 344064
    s_add_u32 m0, s29, 131072
    s_nop 0
    buffer_load_dwordx4 v0, s[60:63], s28 offen lds
    s_mov_b32 s28, 351232
    s_add_u32 m0, s29, 132096
    s_nop 0
    buffer_load_dwordx4 v0, s[60:63], s28 offen lds
    s_mov_b32 s28, 358400
    s_add_u32 m0, s29, 133120
    s_nop 0
    buffer_load_dwordx4 v0, s[60:63], s28 offen lds
    s_mov_b32 s28, 365568
    s_add_u32 m0, s29, 134144
    s_nop 0
    buffer_load_dwordx4 v0, s[60:63], s28 offen lds
    s_add_u32 s8, s29, 49152
    v_add_u32 v10, s8, v1
    s_lshl_b32 s7, s3, 2
    s_add_u32 s7, s7, 45632
    v_mov_b32 v11, s7
    s_mov_b32 s42, 0
    buffer_load_dword v21, v6, s[52:55], 0 offen sc1
    s_waitcnt vmcnt(0)
GH_1:
    v_cmp_eq_u32 vcc, v23, v21
    s_add_u32 s42, s42, 1
    s_cmp_gt_u32 s42, 0x10000
    s_cbranch_scc1 GHOK_2
    s_cmp_eq_u64 vcc, exec
    s_cbranch_scc1 GHOK_2
    s_sleep 8
    buffer_load_dword v21, v6, s[52:55], 0 offen sc1
    s_waitcnt vmcnt(0)
    s_branch GH_1
GHOK_2:
    s_mov_b32 s70, 0
    buffer_load_dwordx4 v[16:19], v7, s[52:55], s70 offen offset:0 sc1
    buffer_load_dwordx4 v[20:23], v5, s[52:55], s70 offen offset:0 sc1
    buffer_load_dwordx4 v[24:27], v7, s[52:55], s70 offen offset:1024 sc1
    buffer_load_dwordx4 v[28:31], v5, s[52:55], s70 offen offset:1024 sc1
    s_mov_b32 s70, 2048
    buffer_load_dwordx4 v[32:35], v7, s[52:55], s70 offen offset:0 sc1
    buffer_load_dwordx4 v[36:39], v5, s[52:55], s70 offen offset:0 sc1
    buffer_load_dwordx4 v[40:43], v7, s[52:55], s70 offen offset:1024 sc1
    buffer_load_dwordx4 v[44:47], v5, s[52:55], s70 offen offset:1024 sc1
    s_mov_b32 s70, 4096
    buffer_load_dwordx4 v[48:51], v7, s[52:55], s70 offen offset:0 sc1
    buffer_load_dwordx4 v[52:55], v5, s[52:55], s70 offen offset:0 sc1
    buffer_load_dwordx4 v[56:59], v7, s[52:55], s70 offen offset:1024 sc1
    buffer_load_dwordx4 v[60:63], v5, s[52:55], s70 offen offset:1024 sc1
    s_mov_b32 s70, 6144
    buffer_load_dwordx4 v[64:67], v7, s[52:55], s70 offen offset:0 sc1
    buffer_load_dwordx4 v[68:71], v5, s[52:55], s70 offen offset:0 sc1
    buffer_load_dwordx4 v[72:75], v7, s[52:55], s70 offen offset:1024 sc1
    buffer_load_dwordx4 v[76:79], v5, s[52:55], s70 offen offset:1024 sc1
    s_waitcnt vmcnt(12)
    v_mfma_f32_32x32x16_bf16 v[192:207], v[176:179], v[16:19], 0
    v_mfma_f32_32x32x16_bf16 v[224:239], v[176:179], v[20:23], 0
    v_mfma_f32_32x32x16_bf16 v[208:223], v[180:183], v[16:19], 0
    v_mfma_f32_32x32x16_bf16 v[240:255], v[180:183], v[20:23], 0
    v_mfma_f32_32x32x16_bf16 v[192:207], v[184:187], v[24:27], v[192:207]
    v_mfma_f32_32x32x16_bf16 v[224:239], v[184:187], v[28:31], v[224:239]
    v_mfma_f32_32x32x16_bf16 v[208:223], v[188:191], v[24:27], v[208:223]
    v_mfma_f32_32x32x16_bf16 v[240:255], v[188:191], v[28:31], v[240:255]
    s_mov_b32 s70, 8192
    buffer_load_dwordx4 v[80:83], v7, s[52:55], s70 offen offset:0 sc1
    buffer_load_dwordx4 v[84:87], v5, s[52:55], s70 offen offset:0 sc1
    buffer_load_dwordx4 v[88:91], v7, s[52:55], s70 offen offset:1024 sc1
    buffer_load_dwordx4 v[92:95], v5, s[52:55], s70 offen offset:1024 sc1
    s_waitcnt vmcnt(12)
    v_mfma_f32_32x32x16_bf16 v[192:207], v[160:163], v[32:35], v[192:207]
    v_mfma_f32_32x32x16_bf16 v[224:239], v[160:163], v[36:39], v[224:239]
    v_mfma_f32_32x32x16_bf16 v[208:223], v[164:167], v[32:35], v[208:223]
    v_mfma_f32_32x32x16_bf16 v[240:255], v[164:167], v[36:39], v[240:255]
    v_mfma_f32_32x32x16_bf16 v[192:207], v[168:171], v[40:43], v[192:207]
    v_mfma_f32_32x32x16_bf16 v[224:239], v[168:171], v[44:47], v[224:239]
    v_mfma_f32_32x32x16_bf16 v[208:223], v[172:175], v[40:43], v[208:223]
    v_mfma_f32_32x32x16_bf16 v[240:255], v[172:175], v[44:47], v[240:255]
    s_mov_b32 s70, 10240
    buffer_load_dwordx4 v[176:179], v7, s[52:55], s70 offen offset:0 sc1
    buffer_load_dwordx4 v[180:183], v5, s[52:55], s70 offen offset:0 sc1
    buffer_load_dwordx4 v[184:187], v7, s[52:55], s70 offen offset:1024 sc1
    buffer_load_dwordx4 v[188:191], v5, s[52:55], s70 offen offset:1024 sc1
    s_waitcnt vmcnt(12)
    v_mfma_f32_32x32x16_bf16 v[192:207], v[144:147], v[48:51], v[192:207]
    v_mfma_f32_32x32x16_bf16 v[224:239], v[144:147], v[52:55], v[224:239]
    v_mfma_f32_32x32x16_bf16 v[208:223], v[148:151], v[48:51], v[208:223]
    v_mfma_f32_32x32x16_bf16 v[240:255], v[148:151], v[52:55], v[240:255]
    v_mfma_f32_32x32x16_bf16 v[192:207], v[152:155], v[56:59], v[192:207]
    v_mfma_f32_32x32x16_bf16 v[224:239], v[152:155], v[60:63], v[224:239]
    v_mfma_f32_32x32x16_bf16 v[208:223], v[156:159], v[56:59], v[208:223]
    v_mfma_f32_32x32x16_bf16 v[240:255], v[156:159], v[60:63], v[240:255]
    s_mov_b32 s70, 12288
    buffer_load_dwordx4 v[16:19], v7, s[52:55], s70 offen offset:0 sc1
    buffer_load_dwordx4 v[20:23], v5, s[52:55], s70 offen offset:0 sc1
    buffer_load_dwordx4 v[24:27], v7, s[52:55], s70 offen offset:1024 sc1
    buffer_load_dwordx4 v[28:31], v5, s[52:55], s70 offen offset:1024 sc1
    s_waitcnt vmcnt(12)
    v_mfma_f32_32x32x16_bf16 v[192:207], v[128:131], v[64:67], v[192:207]
    v_mfma_f32_32x32x16_bf16 v[224:239], v[128:131], v[68:71], v[224:239]
    v_mfma_f32_32x32x16_bf16 v[208:223], v[132:135], v[64:67], v[208:223]
    v_mfma_f32_32x32x16_bf16 v[240:255], v[132:135], v[68:71], v[240:255]
    v_mfma_f32_32x32x16_bf16 v[192:207], v[136:139], v[72:75], v[192:207]
    v_mfma_f32_32x32x16_bf16 v[224:239], v[136:139], v[76:79], v[224:239]
    v_mfma_f32_32x32x16_bf16 v[208:223], v[140:143], v[72:75], v[208:223]
    v_mfma_f32_32x32x16_bf16 v[240:255], v[140:143], v[76:79], v[240:255]
    s_mov_b32 s70, 14336
    buffer_load_dwordx4 v[160:163], v7, s[52:55], s70 offen offset:0 sc1
    buffer_load_dwordx4 v[164:167], v5, s[52:55], s70 offen offset:0 sc1
    buffer_load_dwordx4 v[168:171], v7, s[52:55], s70 offen offset:1024 sc1
    buffer_load_dwordx4 v[172:175], v5, s[52:55], s70 offen offset:1024 sc1
    s_waitcnt vmcnt(12)
    v_mfma_f32_32x32x16_bf16 v[192:207], v[112:115], v[80:83], v[192:207]
    v_mfma_f32_32x32x16_bf16 v[224:239], v[112:115], v[84:87], v[224:239]
    v_mfma_f32_32x32x16_bf16 v[208:223], v[116:119], v[80:83], v[208:223]
    v_mfma_f32_32x32x16_bf16 v[240:255], v[116:119], v[84:87], v[240:255]
    v_mfma_f32_32x32x16_bf16 v[192:207], v[120:123], v[88:91], v[192:207]
    v_mfma_f32_32x32x16_bf16 v[224:239], v[120:123], v[92:95], v[224:239]
    v_mfma_f32_32x32x16_bf16 v[208:223], v[124:127], v[88:91], v[208:223]
    v_mfma_f32_32x32x16_bf16 v[240:255], v[124:127], v[92:95], v[240:255]
    s_mov_b32 s70, 16384
    buffer_load_dwordx4 v[144:147], v7, s[52:55], s70 offen offset:0 sc1
    buffer_load_dwordx4 v[148:151], v5, s[52:55], s70 offen offset:0 sc1
    buffer_load_dwordx4 v[152:155], v7, s[52:55], s70 offen offset:1024 sc1
    buffer_load_dwordx4 v[156:159], v5, s[52:55], s70 offen offset:1024 sc1
    v_add_u32 v3, 147456, v8
    v_xor_b32 v4, 64, v3
    ds_read_b64_tr_b16 v[32:33], v3 offset:0
    ds_read_b64_tr_b16 v[34:35], v3 offset:1024
    ds_read_b64_tr_b16 v[36:37], v4 offset:0
    ds_read_b64_tr_b16 v[38:39], v4 offset:1024
    ds_read_b64_tr_b16 v[40:41], v3 offset:2048
    ds_read_b64_tr_b16 v[42:43], v3 offset:3072
    ds_read_b64_tr_b16 v[44:45], v4 offset:2048
    ds_read_b64_tr_b16 v[46:47], v4 offset:3072
    s_waitcnt lgkmcnt(0)
    s_mov_b32 s28, 372736
    s_add_u32 m0, s29, 147456
    s_nop 0
    buffer_load_dwordx4 v0, s[60:63], s28 offen lds
    s_mov_b32 s28, 379904
    s_add_u32 m0, s29, 148480
    s_nop 0
    buffer_load_dwordx4 v0, s[60:63], s28 offen lds
    s_mov_b32 s28, 387072
    s_add_u32 m0, s29, 149504
    s_nop 0
    buffer_load_dwordx4 v0, s[60:63], s28 offen lds
    s_mov_b32 s28, 394240
    s_add_u32 m0, s29, 150528
    s_nop 0
    buffer_load_dwordx4 v0, s[60:63], s28 offen lds
    s_waitcnt vmcnt(16)
    v_mfma_f32_32x32x16_bf16 v[192:207], v[96:99], v[176:179], v[192:207]
    v_mfma_f32_32x32x16_bf16 v[224:239], v[96:99], v[180:183], v[224:239]
    v_mfma_f32_32x32x16_bf16 v[208:223], v[100:103], v[176:179], v[208:223]
    v_mfma_f32_32x32x16_bf16 v[240:255], v[100:103], v[180:183], v[240:255]
    v_mfma_f32_32x32x16_bf16 v[192:207], v[104:107], v[184:187], v[192:207]
    v_mfma_f32_32x32x16_bf16 v[224:239], v[104:107], v[188:191], v[224:239]
    v_mfma_f32_32x32x16_bf16 v[208:223], v[108:111], v[184:187], v[208:223]
    v_mfma_f32_32x32x16_bf16 v[240:255], v[108:111], v[188:191], v[240:255]
    s_mov_b32 s70, 18432
    buffer_load_dwordx4 v[128:131], v7, s[52:55], s70 offen offset:0 sc1
    buffer_load_dwordx4 v[132:135], v5, s[52:55], s70 offen offset:0 sc1
    buffer_load_dwordx4 v[136:139], v7, s[52:55], s70 offen offset:1024 sc1
    buffer_load_dwordx4 v[140:143], v5, s[52:55], s70 offen offset:1024 sc1
    v_add_u32 v3, 49152, v8
    v_xor_b32 v4, 64, v3
    ds_read_b64_tr_b16 v[48:49], v3 offset:0
    ds_read_b64_tr_b16 v[50:51], v3 offset:1024
    ds_read_b64_tr_b16 v[52:53], v4 offset:0
    ds_read_b64_tr_b16 v[54:55], v4 offset:1024
    ds_read_b64_tr_b16 v[56:57], v3 offset:2048
    ds_read_b64_tr_b16 v[58:59], v3 offset:3072
    ds_read_b64_tr_b16 v[60:61], v4 offset:2048
    ds_read_b64_tr_b16 v[62:63], v4 offset:3072
    s_waitcnt vmcnt(16)
    s_waitcnt lgkmcnt(8)
    v_mfma_f32_32x32x16_bf16 v[192:207], v[32:35], v[16:19], v[192:207]
    v_mfma_f32_32x32x16_bf16 v[224:239], v[32:35], v[20:23], v[224:239]
    v_mfma_f32_32x32x16_bf16 v[208:223], v[36:39], v[16:19], v[208:223]
    v_mfma_f32_32x32x16_bf16 v[240:255], v[36:39], v[20:23], v[240:255]
    v_mfma_f32_32x32x16_bf16 v[192:207], v[40:43], v[24:27], v[192:207]
    v_mfma_f32_32x32x16_bf16 v[224:239], v[40:43], v[28:31], v[224:239]
    v_mfma_f32_32x32x16_bf16 v[208:223], v[44:47], v[24:27], v[208:223]
    v_mfma_f32_32x32x16_bf16 v[240:255], v[44:47], v[28:31], v[240:255]
    s_mov_b32 s70, 20480
    buffer_load_dwordx4 v[112:115], v7, s[52:55], s70 offen offset:0 sc1
    buffer_load_dwordx4 v[116:119], v5, s[52:55], s70 offen offset:0 sc1
    buffer_load_dwordx4 v[120:123], v7, s[52:55], s70 offen offset:1024 sc1
    buffer_load_dwordx4 v[124:127], v5, s[52:55], s70 offen offset:1024 sc1
    v_add_u32 v3, 65536, v8
    v_xor_b32 v4, 64, v3
    ds_read_b64_tr_b16 v[64:65], v3 offset:0
    ds_read_b64_tr_b16 v[66:67], v3 offset:1024
    ds_read_b64_tr_b16 v[68:69], v4 offset:0
    ds_read_b64_tr_b16 v[70:71], v4 offset:1024
    ds_read_b64_tr_b16 v[72:73], v3 offset:2048
    ds_read_b64_tr_b16 v[74:75], v3 offset:3072
    ds_read_b64_tr_b16 v[76:77], v4 offset:2048
    ds_read_b64_tr_b16 v[78:79], v4 offset:3072
    s_waitcnt vmcnt(16)
    s_waitcnt lgkmcnt(8)
    v_mfma_f32_32x32x16_bf16 v[192:207], v[48:51], v[160:163], v[192:207]
    v_mfma_f32_32x32x16_bf16 v[224:239], v[48:51], v[164:167], v[224:239]
    v_mfma_f32_32x32x16_bf16 v[208:223], v[52:55], v[160:163], v[208:223]
    v_mfma_f32_32x32x16_bf16 v[240:255], v[52:55], v[164:167], v[240:255]
    v_mfma_f32_32x32x16_bf16 v[192:207], v[56:59], v[168:171], v[192:207]
    v_mfma_f32_32x32x16_bf16 v[224:239], v[56:59], v[172:175], v[224:239]
    v_mfma_f32_32x32x16_bf16 v[208:223], v[60:63], v[168:171], v[208:223]
    v_mfma_f32_32x32x16_bf16 v[240:255], v[60:63], v[172:175], v[240:255]
    s_mov_b32 s70, 22528
    buffer_load_dwordx4 v[96:99], v7, s[52:55], s70 offen offset:0 sc1
    buffer_load_dwordx4 v[100:103], v5, s[52:55], s70 offen offset:0 sc1
    buffer_load_dwordx4 v[104:107], v7, s[52:55], s70 offen offset:1024 sc1
    buffer_load_dwordx4 v[108:111], v5, s[52:55], s70 offen offset:1024 sc1
    v_add_u32 v3, 81920, v8
    v_xor_b32 v4, 64, v3
    ds_read_b64_tr_b16 v[80:81], v3 offset:0
    ds_read_b64_tr_b16 v[82:83], v3 offset:1024
    ds_read_b64_tr_b16 v[84:85], v4 offset:0
    ds_read_b64_tr_b16 v[86:87], v4 offset:1024
    ds_read_b64_tr_b16 v[88:89], v3 offset:2048
    ds_read_b64_tr_b16 v[90:91], v3 offset:3072
    ds_read_b64_tr_b16 v[92:93], v4 offset:2048
    ds_read_b64_tr_b16 v[94:95], v4 offset:3072
    s_waitcnt vmcnt(16)
    s_waitcnt lgkmcnt(8)
    v_mfma_f32_32x32x16_bf16 v[192:207], v[64:67], v[144:147], v[192:207]
    v_mfma_f32_32x32x16_bf16 v[224:239], v[64:67], v[148:151], v[224:239]
    v_mfma_f32_32x32x16_bf16 v[208:223], v[68:71], v[144:147], v[208:223]
    v_mfma_f32_32x32x16_bf16 v[240:255], v[68:71], v[148:151], v[240:255]
    v_mfma_f32_32x32x16_bf16 v[192:207], v[72:75], v[152:155], v[192:207]
    v_mfma_f32_32x32x16_bf16 v[224:239], v[72:75], v[156:159], v[224:239]
    v_mfma_f32_32x32x16_bf16 v[208:223], v[76:79], v[152:155], v[208:223]
    v_mfma_f32_32x32x16_bf16 v[240:255], v[76:79], v[156:159], v[240:255]
    ds_write_b32 v11, v9 offset:16
    s_mov_b32 s70, 24576
    buffer_load_dwordx4 v[32:35], v7, s[52:55], s70 offen offset:0 sc1
    buffer_load_dwordx4 v[36:39], v5, s[52:55], s70 offen offset:0 sc1
    buffer_load_dwordx4 v[40:43], v7, s[52:55], s70 offen offset:1024 sc1
    buffer_load_dwordx4 v[44:47], v5, s[52:55], s70 offen offset:1024 sc1
    v_add_u32 v3, 98304, v8
    v_xor_b32 v4, 64, v3
    ds_read_b64_tr_b16 v[176:177], v3 offset:0
    ds_read_b64_tr_b16 v[178:179], v3 offset:1024
    ds_read_b64_tr_b16 v[180:181], v4 offset:0
    ds_read_b64_tr_b16 v[182:183], v4 offset:1024
    ds_read_b64_tr_b16 v[184:185], v3 offset:2048
    ds_read_b64_tr_b16 v[186:187], v3 offset:3072
    ds_read_b64_tr_b16 v[188:189], v4 offset:2048
    ds_read_b64_tr_b16 v[190:191], v4 offset:3072
    s_waitcnt vmcnt(12)
    s_waitcnt lgkmcnt(8)
    v_mfma_f32_32x32x16_bf16 v[192:207], v[80:83], v[128:131], v[192:207]
    v_mfma_f32_32x32x16_bf16 v[224:239], v[80:83], v[132:135], v[224:239]
    v_mfma_f32_32x32x16_bf16 v[208:223], v[84:87], v[128:131], v[208:223]
    v_mfma_f32_32x32x16_bf16 v[240:255], v[84:87], v[132:135], v[240:255]
    v_mfma_f32_32x32x16_bf16 v[192:207], v[88:91], v[136:139], v[192:207]
    v_mfma_f32_32x32x16_bf16 v[224:239], v[88:91], v[140:143], v[224:239]
    v_mfma_f32_32x32x16_bf16 v[208:223], v[92:95], v[136:139], v[208:223]
    v_mfma_f32_32x32x16_bf16 v[240:255], v[92:95], v[140:143], v[240:255]
    s_mov_b32 s70, 26624
    buffer_load_dwordx4 v[48:51], v7, s[52:55], s70 offen offset:0 sc1
    buffer_load_dwordx4 v[52:55], v5, s[52:55], s70 offen offset:0 sc1
    buffer_load_dwordx4 v[56:59], v7, s[52:55], s70 offen offset:1024 sc1
    buffer_load_dwordx4 v[60:63], v5, s[52:55], s70 offen offset:1024 sc1
    v_add_u32 v3, 114688, v8
    v_xor_b32 v4, 64, v3
    ds_read_b64_tr_b16 v[16:17], v3 offset:0
    ds_read_b64_tr_b16 v[18:19], v3 offset:1024
    ds_read_b64_tr_b16 v[20:21], v4 offset:0
    ds_read_b64_tr_b16 v[22:23], v4 offset:1024
    ds_read_b64_tr_b16 v[24:25], v3 offset:2048
    ds_read_b64_tr_b16 v[26:27], v3 offset:3072
    ds_read_b64_tr_b16 v[28:29], v4 offset:2048
    ds_read_b64_tr_b16 v[30:31], v4 offset:3072
    s_waitcnt vmcnt(12)
    s_waitcnt lgkmcnt(8)
    v_mfma_f32_32x32x16_bf16 v[192:207], v[176:179], v[112:115], v[192:207]
    v_mfma_f32_32x32x16_bf16 v[224:239], v[176:179], v[116:119], v[224:239]
    v_mfma_f32_32x32x16_bf16 v[208:223], v[180:183], v[112:115], v[208:223]
    v_mfma_f32_32x32x16_bf16 v[240:255], v[180:183], v[116:119], v[240:255]
    v_mfma_f32_32x32x16_bf16 v[192:207], v[184:187], v[120:123], v[192:207]
    v_mfma_f32_32x32x16_bf16 v[224:239], v[184:187], v[124:127], v[224:239]
    v_mfma_f32_32x32x16_bf16 v[208:223], v[188:191], v[120:123], v[208:223]
    v_mfma_f32_32x32x16_bf16 v[240:255], v[188:191], v[124:127], v[240:255]
    v_add_u32 v3, 131072, v8
    v_xor_b32 v4, 64, v3
    ds_read_b64_tr_b16 v[160:161], v3 offset:0
    ds_read_b64_tr_b16 v[162:163], v3 offset:1024
    ds_read_b64_tr_b16 v[164:165], v4 offset:0
    ds_read_b64_tr_b16 v[166:167], v4 offset:1024
    ds_read_b64_tr_b16 v[168:169], v3 offset:2048
    ds_read_b64_tr_b16 v[170:171], v3 offset:3072
    ds_read_b64_tr_b16 v[172:173], v4 offset:2048
    ds_read_b64_tr_b16 v[174:175], v4 offset:3072
    v_add_u32 v3, 147456, v8
    v_xor_b32 v4, 64, v3
    ds_read_b64_tr_b16 v[64:65], v3 offset:0
    ds_read_b64_tr_b16 v[66:67], v3 offset:1024
    ds_read_b64_tr_b16 v[68:69], v4 offset:0
    ds_read_b64_tr_b16 v[70:71], v4 offset:1024
    ds_read_b64_tr_b16 v[72:73], v3 offset:2048
    ds_read_b64_tr_b16 v[74:75], v3 offset:3072
    ds_read_b64_tr_b16 v[76:77], v4 offset:2048
    ds_read_b64_tr_b16 v[78:79], v4 offset:3072
    s_waitcnt vmcnt(8)
    s_waitcnt lgkmcnt(15)
    v_mfma_f32_32x32x16_bf16 v[192:207], v[16:19], v[96:99], v[192:207]
    v_mfma_f32_32x32x16_bf16 v[224:239], v[16:19], v[100:103], v[224:239]
    v_mfma_f32_32x32x16_bf16 v[208:223], v[20:23], v[96:99], v[208:223]
    v_mfma_f32_32x32x16_bf16 v[240:255], v[20:23], v[100:103], v[240:255]
    v_mfma_f32_32x32x16_bf16 v[192:207], v[24:27], v[104:107], v[192:207]
    v_mfma_f32_32x32x16_bf16 v[224:239], v[24:27], v[108:111], v[224:239]
    v_mfma_f32_32x32x16_bf16 v[208:223], v[28:31], v[104:107], v[208:223]
    v_mfma_f32_32x32x16_bf16 v[240:255], v[28:31], v[108:111], v[240:255]
    s_waitcnt vmcnt(4)
    s_waitcnt lgkmcnt(8)
    v_mfma_f32_32x32x16_bf16 v[192:207], v[160:163], v[32:35], v[192:207]
    v_mfma_f32_32x32x16_bf16 v[224:239], v[160:163], v[36:39], v[224:239]
    v_mfma_f32_32x32x16_bf16 v[208:223], v[164:167], v[32:35], v[208:223]
    v_mfma_f32_32x32x16_bf16 v[240:255], v[164:167], v[36:39], v[240:255]
    v_mfma_f32_32x32x16_bf16 v[192:207], v[168:171], v[40:43], v[192:207]
    v_mfma_f32_32x32x16_bf16 v[224:239], v[168:171], v[44:47], v[224:239]
    v_mfma_f32_32x32x16_bf16 v[208:223], v[172:175], v[40:43], v[208:223]
    v_mfma_f32_32x32x16_bf16 v[240:255], v[172:175], v[44:47], v[240:255]
    s_waitcnt vmcnt(0)
    s_waitcnt lgkmcnt(0)
    v_mfma_f32_32x32x16_bf16 v[192:207], v[64:67], v[48:51], v[192:207]
    v_mfma_f32_32x32x16_bf16 v[224:239], v[64:67], v[52:55], v[224:239]
    v_mfma_f32_32x32x16_bf16 v[208:223], v[68:71], v[48:51], v[208:223]
    v_mfma_f32_32x32x16_bf16 v[240:255], v[68:71], v[52:55], v[240:255]
    v_mfma_f32_32x32x16_bf16 v[192:207], v[72:75], v[56:59], v[192:207]
    v_mfma_f32_32x32x16_bf16 v[224:239], v[72:75], v[60:63], v[224:239]
    v_mfma_f32_32x32x16_bf16 v[208:223], v[76:79], v[56:59], v[208:223]
    v_mfma_f32_32x32x16_bf16 v[240:255], v[76:79], v[60:63], v[240:255]
    s_nop 7
    s_nop 3
    ds_write_b128 v10, v[192:195] offset:0
    ds_write_b128 v10, v[196:199] offset:1024
    ds_write_b128 v10, v[200:203] offset:2048
    ds_write_b128 v10, v[204:207] offset:3072
    ds_write_b128 v10, v[208:211] offset:16384
    ds_write_b128 v10, v[212:215] offset:17408
    ds_write_b128 v10, v[216:219] offset:18432
    ds_write_b128 v10, v[220:223] offset:19456
    ds_write_b128 v10, v[224:227] offset:32768
    ds_write_b128 v10, v[228:231] offset:33792
    ds_write_b128 v10, v[232:235] offset:34816
    ds_write_b128 v10, v[236:239] offset:35840
    ds_write_b128 v10, v[240:243] offset:49152
    ds_write_b128 v10, v[244:247] offset:50176
    ds_write_b128 v10, v[248:251] offset:51200
    ds_write_b128 v10, v[252:255] offset:52224
    s_waitcnt lgkmcnt(0)
    ds_write_b32 v11, v9
    s_endpgm
K_B:
    s_mov_b32 s12, 229376
    s_add_u32 m0, s14, 49152
    s_nop 0
    buffer_load_dwordx4 v248, s[48:51], s12 offen lds
    s_mov_b32 s12, 243712
    s_add_u32 m0, s14, 50176
    s_nop 0
    buffer_load_dwordx4 v248, s[48:51], s12 offen lds
    s_mov_b32 s11, 128
    s_add_u32 m0, s13, 49152
    s_nop 0
    buffer_load_dwordx4 v246, s[44:47], s11 offen lds
    s_mov_b32 s12, 258048
    s_add_u32 m0, s14, 51200
    s_nop 0
    buffer_load_dwordx4 v248, s[48:51], s12 offen lds
    s_mov_b32 s12, 272384
    s_add_u32 m0, s14, 52224
    s_nop 0
    buffer_load_dwordx4 v248, s[48:51], s12 offen lds
    s_mov_b32 s11, 128
    s_add_u32 m0, s13, 50176
    s_nop 0
    buffer_load_dwordx4 v247, s[44:47], s11 offen lds
    s_mov_b32 s12, 286720
    s_add_u32 m0, s14, 53248
    s_nop 0
    buffer_load_dwordx4 v248, s[48:51], s12 offen lds
    s_mov_b32 s12, 301056
    s_add_u32 m0, s14, 54272
    s_nop 0
    buffer_load_dwordx4 v248, s[48:51], s12 offen lds
    s_mov_b32 s11, 14464
    s_add_u32 m0, s13, 51200
    s_nop 0
    buffer_load_dwordx4 v246, s[44:47], s11 offen lds
    s_mov_b32 s12, 315392
    s_add_u32 m0, s14, 55296
    s_nop 0
    buffer_load_dwordx4 v248, s[48:51], s12 offen lds
    s_mov_b32 s12, 329728
    s_add_u32 m0, s14, 56320
    s_nop 0
    buffer_load_dwordx4 v248, s[48:51], s12 offen lds
    s_mov_b32 s11, 14464
    s_add_u32 m0, s13, 52224
    s_nop 0
    buffer_load_dwordx4 v247, s[44:47], s11 offen lds
    s_mov_b32 s52, s40
    s_and_b32 s53, s41, 0xffff
    s_mov_b32 s54, 13631488
    s_mov_b32 s55, 0x20000
    s_mov_b32 s56, s38
    s_and_b32 s57, s39, 0xffff
    s_mov_b32 s58, 256
    s_mov_b32 s59, 0x20000
    s_setprio 2
    s_lshl_b32 s7, s10, 12
    s_lshl_b32 s20, s2, 1
    s_add_u32 s20, s20, s69
    s_mul_i32 s21, s69, 6144
    s_add_u32 s21, s21, 33280
    s_mul_i32 s22, s69, 16640
    s_lshl_b32 s7, s20, 12
    s_add_u32 s92, s24, s7
    s_addc_u32 s93, s25, 0
    s_and_b32 s93, s93, 0xffff
    s_mov_b32 s94, 4096
    s_mov_b32 s95, 0x20000
    s_lshl_b32 s8, s2, 2
    s_load_dword s23, s[26:27], s8
    s_lshl_b32 s8, s68, 11
    v_add_u32 v7, s8, v1
    v_subrev_u32 v8, 64, v1
    v_subrev_u32 v9, 48, v1
    s_add_u32 s7, s7, 8388608
    v_add_u32 v228, s7, v7
    buffer_load_dwordx4 v[144:147], v7, s[92:95], 0 offen
    buffer_load_dwordx4 v[148:151], v7, s[92:95], 0 offen offset:16
    buffer_load_dwordx4 v[152:155], v7, s[92:95], 0 offen offset:1024
    buffer_load_dwordx4 v[156:159], v7, s[92:95], 0 offen offset:1040
    buffer_load_dwordx4 v[160:163], v8, s[92:95], 0 offen
    buffer_load_dwordx4 v[164:167], v9, s[92:95], 0 offen
    v_add_u32 v223, s22, v7
    v_add_u32 v224, s22, v1
    v_mov_b32 v212, 0
    v_mov_b32 v213, 0
    v_mov_b32 v214, 0
    v_mov_b32 v215, 0
    v_lshrrev_b32 v10, 4, v2
    s_lshl_b32 s7, s68, 2
    v_add_u32 v225, s7, v10
    v_mul_u32_u24 v225, 768, v225
    v_and_b32 v6, 15, v2
    v_lshl_add_u32 v225, v6, 4, v225
    v_add_u32 v225, s21, v225
    v_and_b32 v226, 7, v2
    v_xor_b32 v226, 4, v226
    v_mul_u32_u24 v226, 768, v226
    v_lshrrev_b32 v11, 3, v2
    v_lshlrev_b32 v11, 4, v11
    v_sub_u32 v226, v226, v11
    s_lshl_b32 s7, s68, 8
    s_sub_u32 s7, s21, s7
    s_add_u32 s7, s7, 624
    v_add_u32 v226, s7, v226
    v_mul_u32_u24 v217, 768, v10
    v_lshl_add_u32 v217, v6, 4, v217
    v_add_u32 v217, s21, v217
    v_sub_u32 v218, 3, v10
    v_mul_u32_u24 v218, 768, v218
    v_lshl_add_u32 v218, v6, 4, v218
    v_add_u32 v218, s21, v218
    v_lshlrev_b32 v219, 7, v6
    v_lshl_add_u32 v219, v10, 4, v219
    v_lshrrev_b32 v6, 2, v6
    v_add_u32 v6, v6, v10
    v_lshlrev_b32 v6, 4, v6
    v_add_u32 v6, s22, v6
    v_and_b32 v10, 3, v2
    v_mul_u32_u24 v216, 4160, v10
    v_add_u32 v216, v216, v6
    s_lshl_b32 s7, s68, 12
    s_add_u32 s8, s7, s22
    v_add_u32 v220, s8, v1
    s_xor_b32 s7, s7, 4096
    s_add_u32 s8, s7, s22
    v_add_u32 v221, s8, v1
    s_lshl_b32 s7, s69, 5
    s_add_u32 s7, s7, 45568
    v_mov_b32 v222, s7
    s_lshr_b32 s8, s2, 5
    v_lshl_add_u32 v8, v2, 3, s8
    s_lshl_b32 s7, s4, 1
    s_add_u32 s7, s7, 224
    v_add_u32 v9, s7, v2
    v_cmp_le_u32 vcc, 32, v2
    s_sub_u32 s8, s5, 188
    v_mul_u32_u24 v6, 14, v2
    v_cndmask_b32 v8, v8, v9, vcc
    v_add_u32 v9, s8, v6
    v_cmp_le_u32 vcc, 34, v2
    v_mov_b32 v6, s6
    v_add_u32 v6, 256, v6
    s_lshl_b32 s8, s10, 24
    v_cndmask_b32 v8, v8, v9, vcc
    v_cmp_le_u32 vcc, 36, v2
    s_add_u32 s8, s8, 12713984
    s_nop 0
    v_cndmask_b32 v8, v8, v6, vcc
    v_lshl_add_u32 v227, v8, 7, s8
    s_barrier
    s_lshl_b32 s7, s10, 11
    s_add_u32 s7, s7, 147456
    v_add_u32 v26, s7, v1
    ds_read_b128 v[112:115], v26
    ds_read_b128 v[116:119], v26 offset:1024
    v_lshrrev_b32 v26, 3, v2
    v_lshlrev_b32 v26, 12, v26
    v_and_b32 v27, 7, v2
    v_lshl_add_u32 v26, v27, 4, v26
    s_lshl_b32 s7, s9, 6
    s_lshl_b32 s8, s10, 4
    s_add_u32 s7, s7, s8
    s_lshl_b32 s7, s7, 12
    s_lshl_b32 s8, s6, 7
    s_sub_u32 s7, s7, s8
    s_add_u32 s7, s7, 8392576
    s_add_u32 s8, s7, 32768
    s_waitcnt lgkmcnt(0)
    buffer_store_dwordx4 v[112:115], v26, s[52:55], s7 offen sc1
    buffer_store_dwordx4 v[116:119], v26, s[52:55], s8 offen sc1
    s_mov_b64 exec, -1
    s_lshl_b32 s7, s10, 12
    buffer_load_dword v23, v20, s[56:59], s7 offen sc1
    s_mov_b32 s12, 458752
    s_add_u32 m0, s14, 98304
    s_nop 0
    buffer_load_dwordx4 v248, s[48:51], s12 offen lds
    s_mov_b32 s12, 473088
    s_add_u32 m0, s14, 99328
    s_nop 0
    buffer_load_dwordx4 v248, s[48:51], s12 offen lds
    s_mov_b32 s11, 256
    s_add_u32 m0, s13, 98304
    s_nop 0
    buffer_load_dwordx4 v246, s[44:47], s11 offen lds
    s_mov_b32 s12, 487424
    s_add_u32 m0, s14, 100352
    s_nop 0
    buffer_load_dwordx4 v248, s[48:51], s12 offen lds
    s_mov_b32 s12, 501760
    s_add_u32 m0, s14, 101376
    s_nop 0
    buffer_load_dwordx4 v248, s[48:51], s12 offen lds
    s_mov_b32 s11, 256
    s_add_u32 m0, s13, 99328
    s_nop 0
    buffer_load_dwordx4 v247, s[44:47], s11 offen lds
    s_mov_b32 s12, 516096
    s_add_u32 m0, s14, 102400
    s_nop 0
    buffer_load_dwordx4 v248, s[48:51], s12 offen lds
    s_mov_b32 s12, 530432
    s_add_u32 m0, s14, 103424
    s_nop 0
    buffer_load_dwordx4 v248, s[48:51], s12 offen lds
    s_mov_b32 s11, 14592
    s_add_u32 m0, s13, 100352
    s_nop 0
    buffer_load_dwordx4 v246, s[44:47], s11 offen lds
    s_mov_b32 s12, 544768
    s_add_u32 m0, s14, 104448
    s_nop 0
    buffer_load_dwordx4 v248, s[48:51], s12 offen lds
    s_mov_b32 s12, 559104
    s_add_u32 m0, s14, 105472
    s_nop 0
    buffer_load_dwordx4 v248, s[48:51], s12 offen lds
    s_mov_b32 s11, 14592
    s_add_u32 m0, s13, 101376
    s_nop 0
    buffer_load_dwordx4 v247, s[44:47], s11 offen lds
    s_waitcnt vmcnt(12)
    s_cmp_lg_u32 s10, 0
    s_cbranch_scc1 TBSK_5
    s_mov_b32 s42, 0
TB_3:
    v_readfirstlane_b32 s43, v23
    s_add_u32 s42, s42, 1
    s_cmp_gt_u32 s42, 0x4000
    s_cbranch_scc1 TBOK_4
    s_cmp_lg_u32 s43, 0
    s_cbranch_scc1 TBOK_4
    s_sleep 4
    buffer_load_dword v23, v20, s[56:59], 0 offen sc1
    s_waitcnt vmcnt(0)
    s_branch TB_3
TBOK_4:
    v_mov_b32 v6, 155648
    ds_write_b32 v6, v23
TBSK_5:
    s_waitcnt lgkmcnt(0)
    s_barrier
    s_mov_b32 s12, 688128
    s_add_u32 m0, s14, 0
    s_nop 0
    buffer_load_dwordx4 v248, s[48:51], s12 offen lds
    s_mov_b32 s12, 702464
    s_add_u32 m0, s14, 1024
    s_nop 0
    buffer_load_dwordx4 v248, s[48:51], s12 offen lds
    s_mov_b32 s11, 384
    s_add_u32 m0, s13, 0
    s_nop 0
    buffer_load_dwordx4 v246, s[44:47], s11 offen lds
    s_mov_b32 s12, 716800
    s_add_u32 m0, s14, 2048
    s_nop 0
    buffer_load_dwordx4 v248, s[48:51], s12 offen lds
    s_mov_b32 s12, 731136
    s_add_u32 m0, s14, 3072
    s_nop 0
    buffer_load_dwordx4 v248, s[48:51], s12 offen lds
    s_mov_b32 s11, 384
    s_add_u32 m0, s13, 1024
    s_nop 0
    buffer_load_dwordx4 v247, s[44:47], s11 offen lds
    s_mov_b32 s12, 745472
    s_add_u32 m0, s14, 4096
    s_nop 0
    buffer_load_dwordx4 v248, s[48:51], s12 offen lds
    s_mov_b32 s12, 759808
    s_add_u32 m0, s14, 5120
    s_nop 0
    buffer_load_dwordx4 v248, s[48:51], s12 offen lds
    s_mov_b32 s11, 14720
    s_add_u32 m0, s13, 2048
    s_nop 0
    buffer_load_dwordx4 v246, s[44:47], s11 offen lds
    s_mov_b32 s12, 774144
    s_add_u32 m0, s14, 6144
    s_nop 0
    buffer_load_dwordx4 v248, s[48:51], s12 offen lds
    s_mov_b32 s12, 788480
    s_add_u32 m0, s14, 7168
    s_nop 0
    buffer_load_dwordx4 v248, s[48:51], s12 offen lds
    s_mov_b32 s11, 14720
    s_add_u32 m0, s13, 3072
    s_nop 0
    buffer_load_dwordx4 v247, s[44:47], s11 offen lds
    v_mov_b32 v6, 155648
    ds_read_b32 v23, v6
    s_waitcnt lgkmcnt(0)
    s_waitcnt vmcnt(12)
    s_barrier
    s_mov_b32 s12, 917504
    s_add_u32 m0, s14, 49152
    s_nop 0
    buffer_load_dwordx4 v248, s[48:51], s12 offen lds
    s_mov_b32 s12, 931840
    s_add_u32 m0, s14, 50176
    s_nop 0
    buffer_load_dwordx4 v248, s[48:51], s12 offen lds
    s_mov_b32 s11, 512
    s_add_u32 m0, s13, 49152
    s_nop 0
    buffer_load_dwordx4 v246, s[44:47], s11 offen lds
    s_mov_b32 s12, 946176
    s_add_u32 m0, s14, 51200
    s_nop 0
    buffer_load_dwordx4 v248, s[48:51], s12 offen lds
    s_mov_b32 s12, 960512
    s_add_u32 m0, s14, 52224
    s_nop 0
    buffer_load_dwordx4 v248, s[48:51], s12 offen lds
    s_mov_b32 s11, 512
    s_add_u32 m0, s13, 50176
    s_nop 0
    buffer_load_dwordx4 v247, s[44:47], s11 offen lds
    s_mov_b32 s12, 974848
    s_add_u32 m0, s14, 53248
    s_nop 0
    buffer_load_dwordx4 v248, s[48:51], s12 offen lds
    s_mov_b32 s12, 989184
    s_add_u32 m0, s14, 54272
    s_nop 0
    buffer_load_dwordx4 v248, s[48:51], s12 offen lds
    s_mov_b32 s11, 14848
    s_add_u32 m0, s13, 51200
    s_nop 0
    buffer_load_dwordx4 v246, s[44:47], s11 offen lds
    s_mov_b32 s12, 1003520
    s_add_u32 m0, s14, 55296
    s_nop 0
    buffer_load_dwordx4 v248, s[48:51], s12 offen lds
    s_mov_b32 s12, 1017856
    s_add_u32 m0, s14, 56320
    s_nop 0
    buffer_load_dwordx4 v248, s[48:51], s12 offen lds
    s_mov_b32 s11, 14848
    s_add_u32 m0, s13, 52224
    s_nop 0
    buffer_load_dwordx4 v247, s[44:47], s11 offen lds
    s_waitcnt lgkmcnt(0)
    s_waitcnt vmcnt(12)
    s_barrier
    s_mov_b32 s12, 1146880
    s_add_u32 m0, s14, 98304
    s_nop 0
    buffer_load_dwordx4 v248, s[48:51], s12 offen lds
    s_mov_b32 s12, 1161216
    s_add_u32 m0, s14, 99328
    s_nop 0
    buffer_load_dwordx4 v248, s[48:51], s12 offen lds
    s_mov_b32 s11, 640
    s_add_u32 m0, s13, 98304
    s_nop 0
    buffer_load_dwordx4 v246, s[44:47], s11 offen lds
    s_mov_b32 s12, 1175552
    s_add_u32 m0, s14, 100352
    s_nop 0
    buffer_load_dwordx4 v248, s[48:51], s12 offen lds
    s_mov_b32 s12, 1189888
    s_add_u32 m0, s14, 101376
    s_nop 0
    buffer_load_dwordx4 v248, s[48:51], s12 offen lds
    s_mov_b32 s11, 640
    s_add_u32 m0, s13, 99328
    s_nop 0
    buffer_load_dwordx4 v247, s[44:47], s11 offen lds
    s_mov_b32 s12, 1204224
    s_add_u32 m0, s14, 102400
    s_nop 0
    buffer_load_dwordx4 v248, s[48:51], s12 offen lds
    s_mov_b32 s12, 1218560
    s_add_u32 m0, s14, 103424
    s_nop 0
    buffer_load_dwordx4 v248, s[48:51], s12 offen lds
    s_mov_b32 s11, 14976
    s_add_u32 m0, s13, 100352
    s_nop 0
    buffer_load_dwordx4 v246, s[44:47], s11 offen lds
    s_mov_b32 s12, 1232896
    s_add_u32 m0, s14, 104448
    s_nop 0
    buffer_load_dwordx4 v248, s[48:51], s12 offen lds
    s_mov_b32 s12, 1247232
    s_add_u32 m0, s14, 105472
    s_nop 0
    buffer_load_dwordx4 v248, s[48:51], s12 offen lds
    s_mov_b32 s11, 14976
    s_add_u32 m0, s13, 101376
    s_nop 0
    buffer_load_dwordx4 v247, s[44:47], s11 offen lds
    s_cmp_lg_u32 s10, 0
    s_cbranch_scc1 NOSIG_6
    s_lshl_b32 s7, s6, 3
    s_add_u32 s7, s7, s9
    s_lshl_b32 s7, s7, 7
    s_add_u32 s7, s7, 12713984
    s_mov_b64 exec, 1
    buffer_store_dword v23, v20, s[52:55], s7 offen sc1
    s_mov_b64 exec, -1
NOSIG_6:
    s_waitcnt lgkmcnt(0)
    s_waitcnt vmcnt(12)
    s_barrier
    s_mov_b32 s12, 1376256
    s_add_u32 m0, s14, 0
    s_nop 0
    buffer_load_dwordx4 v248, s[48:51], s12 offen lds
    s_mov_b32 s12, 1390592
    s_add_u32 m0, s14, 1024
    s_nop 0
    buffer_load_dwordx4 v248, s[48:51], s12 offen lds
    s_mov_b32 s11, 768
    s_add_u32 m0, s13, 0
    s_nop 0
    buffer_load_dwordx4 v246, s[44:47], s11 offen lds
    s_mov_b32 s12, 1404928
    s_add_u32 m0, s14, 2048
    s_nop 0
    buffer_load_dwordx4 v248, s[48:51], s12 offen lds
    s_mov_b32 s12, 1419264
    s_add_u32 m0, s14, 3072
    s_nop 0
    buffer_load_dwordx4 v248, s[48:51], s12 offen lds
    s_mov_b32 s11, 768
    s_add_u32 m0, s13, 1024
    s_nop 0
    buffer_load_dwordx4 v247, s[44:47], s11 offen lds
    s_mov_b32 s12, 1433600
    s_add_u32 m0, s14, 4096
    s_nop 0
    buffer_load_dwordx4 v248, s[48:51], s12 offen lds
    s_mov_b32 s12, 1447936
    s_add_u32 m0, s14, 5120
    s_nop 0
    buffer_load_dwordx4 v248, s[48:51], s12 offen lds
    s_mov_b32 s11, 15104
    s_add_u32 m0, s13, 2048
    s_nop 0
    buffer_load_dwordx4 v246, s[44:47], s11 offen lds
    s_mov_b32 s12, 1462272
    s_add_u32 m0, s14, 6144
    s_nop 0
    buffer_load_dwordx4 v248, s[48:51], s12 offen lds
    s_mov_b32 s12, 1476608
    s_add_u32 m0, s14, 7168
    s_nop 0
    buffer_load_dwordx4 v248, s[48:51], s12 offen lds
    s_mov_b32 s11, 15104
    s_add_u32 m0, s13, 3072
    s_nop 0
    buffer_load_dwordx4 v247, s[44:47], s11 offen lds
    v_mov_b32 v176, v145
    v_mov_b32 v177, v146
    v_mov_b32 v178, v147
    v_mov_b32 v179, v148
    v_alignbit_b32 v180, v145, v144, 16
    v_alignbit_b32 v181, v146, v145, 16
    v_alignbit_b32 v182, v147, v146, 16
    v_alignbit_b32 v183, v148, v147, 16
    v_alignbit_b32 v184, v146, v145, 16
    v_alignbit_b32 v185, v147, v146, 16
    v_alignbit_b32 v186, v148, v147, 16
    v_alignbit_b32 v187, v149, v148, 16
    v_mov_b32 v188, v153
    v_mov_b32 v189, v154
    v_mov_b32 v190, v155
    v_mov_b32 v191, v156
    v_alignbit_b32 v192, v153, v152, 16
    v_alignbit_b32 v193, v154, v153, 16
    v_alignbit_b32 v194, v155, v154, 16
    v_alignbit_b32 v195, v156, v155, 16
    v_alignbit_b32 v196, v154, v153, 16
    v_alignbit_b32 v197, v155, v154, 16
    v_alignbit_b32 v198, v156, v155, 16
    v_alignbit_b32 v199, v157, v156, 16
    v_mov_b32 v200, v161
    v_mov_b32 v201, v162
    v_mov_b32 v202, v163
    v_mov_b32 v203, v164
    v_alignbit_b32 v204, v161, v160, 16
    v_alignbit_b32 v205, v162, v161, 16
    v_alignbit_b32 v206, v163, v162, 16
    v_alignbit_b32 v207, v164, v163, 16
    v_alignbit_b32 v208, v162, v161, 16
    v_alignbit_b32 v209, v163, v162, 16
    v_alignbit_b32 v210, v164, v163, 16
    v_alignbit_b32 v211, v165, v164, 16
    s_waitcnt lgkmcnt(0)
    s_waitcnt vmcnt(12)
    s_barrier
    buffer_load_dword v21, v227, s[52:55], 0 offen sc1
    s_waitcnt lgkmcnt(0)
    s_waitcnt vmcnt(1)
    s_waitcnt vmcnt(0)
    s_cmp_lg_u32 s10, 0
    s_cbranch_scc1 NOCS_7
    s_mov_b32 s42, 0
BC_8:
    v_cmp_eq_u32 vcc, v23, v21
    s_add_u32 s42, s42, 1
    s_cmp_gt_u32 s42, 0x10000
    s_cbranch_scc1 BCOK_9
    s_cmp_eq_u64 vcc, exec
    s_cbranch_scc1 BCOK_9
    s_sleep 4
    buffer_load_dword v21, v227, s[52:55], 0 offen sc1
    s_waitcnt vmcnt(0)
    s_branch BC_8
BCOK_9:
    s_mov_b64 exec, -1
NOCS_7:
    s_barrier
    buffer_load_dwordx4 v[168:171], v228, s[52:55], 0 offen sc1
    buffer_load_dwordx4 v[172:175], v228, s[52:55], 0 offen offset:1024 sc1
    s_waitcnt lgkmcnt(0)
    s_barrier
    ds_write_b128 v223, v[180:183] offset:64
    ds_write_b128 v223, v[176:179] offset:4224
    ds_write_b128 v223, v[184:187] offset:8384
    ds_write_b128 v223, v[146:149] offset:12544
    ds_write_b128 v223, v[192:195] offset:1088
    ds_write_b128 v223, v[188:191] offset:5248
    ds_write_b128 v223, v[196:199] offset:9408
    ds_write_b128 v223, v[154:157] offset:13568
    s_mov_b64 exec, 15
    ds_write_b128 v224, v[204:207] offset:0
    ds_write_b128 v224, v[200:203] offset:4160
    ds_write_b128 v224, v[208:211] offset:8320
    ds_write_b128 v224, v[162:165] offset:12480
    s_mov_b64 exec, -1
    ds_write_b128 v225, v[212:215]
    s_waitcnt vmcnt(0)
    ds_write_b128 v226, v[168:171] offset:128
    ds_write_b128 v226, v[172:175]
    s_waitcnt lgkmcnt(0)
    s_cmp_eq_u32 s68, 1
    s_cbranch_scc1 C_HALF1
    ds_write_b32 v222, v23 offset:0
    s_mov_b32 s42, 0
CR_10:
    ds_read_b32 v6, v222 offset:4
    s_add_u32 s42, s42, 1
    s_cmp_gt_u32 s42, 0x100000
    s_cbranch_scc1 CROK_11
    s_waitcnt lgkmcnt(0)
    v_cmp_eq_u32 vcc, v23, v6
    s_nop 3
    s_cmp_eq_u64 vcc, exec
    s_cbranch_scc0 CR_10
CROK_11:
    s_waitcnt lgkmcnt(0)
    ds_read_b128 v[32:35], v216 offset:0
    ds_read_b64 v[36:37], v216 offset:16
    ds_read_b128 v[38:41], v216 offset:64
    ds_read_b64 v[42:43], v216 offset:80
    ds_read_b128 v[68:71], v217 offset:256
    ds_read_b128 v[72:75], v217 offset:512
    ds_read_b128 v[76:79], v217 offset:3328
    ds_read_b128 v[80:83], v217 offset:3584
    ds_read_b128 v[44:47], v216 offset:128
    ds_read_b64 v[48:49], v216 offset:144
    ds_read_b128 v[50:53], v216 offset:192
    ds_read_b64 v[54:55], v216 offset:208
    ds_read_b128 v[84:87], v217 offset:240
    ds_read_b128 v[88:91], v217 offset:496
    ds_read_b128 v[92:95], v217 offset:3312
    ds_read_b128 v[96:99], v217 offset:3568
    s_waitcnt lgkmcnt(8)
    v_mfma_f32_16x16x32_bf16 v[100:103], v[32:35], v[68:71], 0
    v_mfma_f32_16x16x32_bf16 v[116:119], v[32:35], v[72:75], 0
    v_mfma_f32_16x16x32_bf16 v[104:107], v[34:37], v[68:71], 0
    v_mfma_f32_16x16x32_bf16 v[120:123], v[34:37], v[72:75], 0
    v_mfma_f32_16x16x32_bf16 v[108:111], v[38:41], v[68:71], 0
    v_mfma_f32_16x16x32_bf16 v[124:127], v[38:41], v[72:75], 0
    v_mfma_f32_16x16x32_bf16 v[112:115], v[40:43], v[68:71], 0
    v_mfma_f32_16x16x32_bf16 v[128:131], v[40:43], v[72:75], 0
    v_mfma_f32_16x16x32_bf16 v[108:111], v[32:35], v[76:79], v[108:111]
    v_mfma_f32_16x16x32_bf16 v[124:127], v[32:35], v[80:83], v[124:127]
    v_mfma_f32_16x16x32_bf16 v[112:115], v[34:37], v[76:79], v[112:115]
    v_mfma_f32_16x16x32_bf16 v[128:131], v[34:37], v[80:83], v[128:131]
    ds_read_b128 v[56:59], v216 offset:256
    ds_read_b64 v[60:61], v216 offset:272
    ds_read_b128 v[62:65], v216 offset:320
    ds_read_b64 v[66:67], v216 offset:336
    ds_read_b128 v[68:71], v217 offset:224
    ds_read_b128 v[72:75], v217 offset:480
    ds_read_b128 v[76:79], v217 offset:3296
    ds_read_b128 v[80:83], v217 offset:3552
    s_waitcnt lgkmcnt(8)
    v_mfma_f32_16x16x32_bf16 v[100:103], v[44:47], v[84:87], v[100:103]
    v_mfma_f32_16x16x32_bf16 v[116:119], v[44:47], v[88:91], v[116:119]
    v_mfma_f32_16x16x32_bf16 v[104:107], v[46:49], v[84:87], v[104:107]
    v_mfma_f32_16x16x32_bf16 v[120:123], v[46:49], v[88:91], v[120:123]
    v_mfma_f32_16x16x32_bf16 v[108:111], v[50:53], v[84:87], v[108:111]
    v_mfma_f32_16x16x32_bf16 v[124:127], v[50:53], v[88:91], v[124:127]
    v_mfma_f32_16x16x32_bf16 v[112:115], v[52:55], v[84:87], v[112:115]
    v_mfma_f32_16x16x32_bf16 v[128:131], v[52:55], v[88:91], v[128:131]
    v_mfma_f32_16x16x32_bf16 v[100:103], v[38:41], v[92:95], v[100:103]
    v_mfma_f32_16x16x32_bf16 v[116:119], v[38:41], v[96:99], v[116:119]
    v_mfma_f32_16x16x32_bf16 v[104:107], v[40:43], v[92:95], v[104:107]
    v_mfma_f32_16x16x32_bf16 v[120:123], v[40:43], v[96:99], v[120:123]
    v_mfma_f32_16x16x32_bf16 v[108:111], v[44:47], v[92:95], v[108:111]
    v_mfma_f32_16x16x32_bf16 v[124:127], v[44:47], v[96:99], v[124:127]
    v_mfma_f32_16x16x32_bf16 v[112:115], v[46:49], v[92:95], v[112:115]
    v_mfma_f32_16x16x32_bf16 v[128:131], v[46:49], v[96:99], v[128:131]
    ds_read_b128 v[32:35], v216 offset:384
    ds_read_b64 v[36:37], v216 offset:400
    ds_read_b128 v[38:41], v216 offset:448
    ds_read_b64 v[42:43], v216 offset:464
    ds_read_b128 v[84:87], v217 offset:208
    ds_read_b128 v[88:91], v217 offset:464
    ds_read_b128 v[92:95], v217 offset:3280
    ds_read_b128 v[96:99], v217 offset:3536
    s_waitcnt lgkmcnt(8)
    v_mfma_f32_16x16x32_bf16 v[100:103], v[56:59], v[68:71], v[100:103]
    v_mfma_f32_16x16x32_bf16 v[116:119], v[56:59], v[72:75], v[116:119]
    v_mfma_f32_16x16x32_bf16 v[104:107], v[58:61], v[68:71], v[104:107]
    v_mfma_f32_16x16x32_bf16 v[120:123], v[58:61], v[72:75], v[120:123]
    v_mfma_f32_16x16x32_bf16 v[108:111], v[62:65], v[68:71], v[108:111]
    v_mfma_f32_16x16x32_bf16 v[124:127], v[62:65], v[72:75], v[124:127]
    v_mfma_f32_16x16x32_bf16 v[112:115], v[64:67], v[68:71], v[112:115]
    v_mfma_f32_16x16x32_bf16 v[128:131], v[64:67], v[72:75], v[128:131]
    v_mfma_f32_16x16x32_bf16 v[100:103], v[50:53], v[76:79], v[100:103]
    v_mfma_f32_16x16x32_bf16 v[116:119], v[50:53], v[80:83], v[116:119]
    v_mfma_f32_16x16x32_bf16 v[104:107], v[52:55], v[76:79], v[104:107]
    v_mfma_f32_16x16x32_bf16 v[120:123], v[52:55], v[80:83], v[120:123]
    v_mfma_f32_16x16x32_bf16 v[108:111], v[56:59], v[76:79], v[108:111]
    v_mfma_f32_16x16x32_bf16 v[124:127], v[56:59], v[80:83], v[124:127]
    v_mfma_f32_16x16x32_bf16 v[112:115], v[58:61], v[76:79], v[112:115]
    v_mfma_f32_16x16x32_bf16 v[128:131], v[58:61], v[80:83], v[128:131]
    ds_read_b128 v[44:47], v216 offset:512
    ds_read_b64 v[48:49], v216 offset:528
    ds_read_b128 v[50:53], v216 offset:576
    ds_read_b64 v[54:55], v216 offset:592
    ds_read_b128 v[68:71], v217 offset:192
    ds_read_b128 v[72:75], v217 offset:448
    ds_read_b128 v[76:79], v217 offset:3264
    ds_read_b128 v[80:83], v217 offset:3520
    s_waitcnt lgkmcnt(8)
    v_mfma_f32_16x16x32_bf16 v[100:103], v[32:35], v[84:87], v[100:103]
    v_mfma_f32_16x16x32_bf16 v[116:119], v[32:35], v[88:91], v[116:119]
    v_mfma_f32_16x16x32_bf16 v[104:107], v[34:37], v[84:87], v[104:107]
    v_mfma_f32_16x16x32_bf16 v[120:123], v[34:37], v[88:91], v[120:123]
    v_mfma_f32_16x16x32_bf16 v[108:111], v[38:41], v[84:87], v[108:111]
    v_mfma_f32_16x16x32_bf16 v[124:127], v[38:41], v[88:91], v[124:127]
    v_mfma_f32_16x16x32_bf16 v[112:115], v[40:43], v[84:87], v[112:115]
    v_mfma_f32_16x16x32_bf16 v[128:131], v[40:43], v[88:91], v[128:131]
    v_mfma_f32_16x16x32_bf16 v[100:103], v[62:65], v[92:95], v[100:103]
    v_mfma_f32_16x16x32_bf16 v[116:119], v[62:65], v[96:99], v[116:119]
    v_mfma_f32_16x16x32_bf16 v[104:107], v[64:67], v[92:95], v[104:107]
    v_mfma_f32_16x16x32_bf16 v[120:123], v[64:67], v[96:99], v[120:123]
    v_mfma_f32_16x16x32_bf16 v[108:111], v[32:35], v[92:95], v[108:111]
    v_mfma_f32_16x16x32_bf16 v[124:127], v[32:35], v[96:99], v[124:127]
    v_mfma_f32_16x16x32_bf16 v[112:115], v[34:37], v[92:95], v[112:115]
    v_mfma_f32_16x16x32_bf16 v[128:131], v[34:37], v[96:99], v[128:131]
    ds_read_b128 v[56:59], v216 offset:640
    ds_read_b64 v[60:61], v216 offset:656
    ds_read_b128 v[62:65], v216 offset:704
    ds_read_b64 v[66:67], v216 offset:720
    ds_read_b128 v[84:87], v217 offset:176
    ds_read_b128 v[88:91], v217 offset:432
    ds_read_b128 v[92:95], v217 offset:3248
    ds_read_b128 v[96:99], v217 offset:3504
    s_waitcnt lgkmcnt(8)
    v_mfma_f32_16x16x32_bf16 v[100:103], v[44:47], v[68:71], v[100:103]
    v_mfma_f32_16x16x32_bf16 v[116:119], v[44:47], v[72:75], v[116:119]
    v_mfma_f32_16x16x32_bf16 v[104:107], v[46:49], v[68:71], v[104:107]
    v_mfma_f32_16x16x32_bf16 v[120:123], v[46:49], v[72:75], v[120:123]
    v_mfma_f32_16x16x32_bf16 v[108:111], v[50:53], v[68:71], v[108:111]
    v_mfma_f32_16x16x32_bf16 v[124:127], v[50:53], v[72:75], v[124:127]
    v_mfma_f32_16x16x32_bf16 v[112:115], v[52:55], v[68:71], v[112:115]
    v_mfma_f32_16x16x32_bf16 v[128:131], v[52:55], v[72:75], v[128:131]
    v_mfma_f32_16x16x32_bf16 v[100:103], v[38:41], v[76:79], v[100:103]
    v_mfma_f32_16x16x32_bf16 v[116:119], v[38:41], v[80:83], v[116:119]
    v_mfma_f32_16x16x32_bf16 v[104:107], v[40:43], v[76:79], v[104:107]
    v_mfma_f32_16x16x32_bf16 v[120:123], v[40:43], v[80:83], v[120:123]
    v_mfma_f32_16x16x32_bf16 v[108:111], v[44:47], v[76:79], v[108:111]
    v_mfma_f32_16x16x32_bf16 v[124:127], v[44:47], v[80:83], v[124:127]
    v_mfma_f32_16x16x32_bf16 v[112:115], v[46:49], v[76:79], v[112:115]
    v_mfma_f32_16x16x32_bf16 v[128:131], v[46:49], v[80:83], v[128:131]
    ds_read_b128 v[32:35], v216 offset:768
    ds_read_b64 v[36:37], v216 offset:784
    ds_read_b128 v[38:41], v216 offset:832
    ds_read_b64 v[42:43], v216 offset:848
    ds_read_b128 v[68:71], v217 offset:160
    ds_read_b128 v[72:75], v217 offset:416
    ds_read_b128 v[76:79], v217 offset:3232
    ds_read_b128 v[80:83], v217 offset:3488
    s_waitcnt lgkmcnt(8)
    v_mfma_f32_16x16x32_bf16 v[100:103], v[56:59], v[84:87], v[100:103]
    v_mfma_f32_16x16x32_bf16 v[116:119], v[56:59], v[88:91], v[116:119]
    v_mfma_f32_16x16x32_bf16 v[104:107], v[58:61], v[84:87], v[104:107]
    v_mfma_f32_16x16x32_bf16 v[120:123], v[58:61], v[88:91], v[120:123]
    v_mfma_f32_16x16x32_bf16 v[108:111], v[62:65], v[84:87], v[108:111]
    v_mfma_f32_16x16x32_bf16 v[124:127], v[62:65], v[88:91], v[124:127]
    v_mfma_f32_16x16x32_bf16 v[112:115], v[64:67], v[84:87], v[112:115]
    v_mfma_f32_16x16x32_bf16 v[128:131], v[64:67], v[88:91], v[128:131]
    v_mfma_f32_16x16x32_bf16 v[100:103], v[50:53], v[92:95], v[100:103]
    v_mfma_f32_16x16x32_bf16 v[116:119], v[50:53], v[96:99], v[116:119]
    v_mfma_f32_16x16x32_bf16 v[104:107], v[52:55], v[92:95], v[104:107]
    v_mfma_f32_16x16x32_bf16 v[120:123], v[52:55], v[96:99], v[120:123]
    v_mfma_f32_16x16x32_bf16 v[108:111], v[56:59], v[92:95], v[108:111]
    v_mfma_f32_16x16x32_bf16 v[124:127], v[56:59], v[96:99], v[124:127]
    v_mfma_f32_16x16x32_bf16 v[112:115], v[58:61], v[92:95], v[112:115]
    v_mfma_f32_16x16x32_bf16 v[128:131], v[58:61], v[96:99], v[128:131]
    ds_read_b128 v[44:47], v216 offset:896
    ds_read_b64 v[48:49], v216 offset:912
    ds_read_b128 v[50:53], v216 offset:960
    ds_read_b64 v[54:55], v216 offset:976
    ds_read_b128 v[84:87], v217 offset:144
    ds_read_b128 v[88:91], v217 offset:400
    ds_read_b128 v[92:95], v217 offset:3216
    ds_read_b128 v[96:99], v217 offset:3472
    s_waitcnt lgkmcnt(8)
    v_mfma_f32_16x16x32_bf16 v[100:103], v[32:35], v[68:71], v[100:103]
    v_mfma_f32_16x16x32_bf16 v[116:119], v[32:35], v[72:75], v[116:119]
    v_mfma_f32_16x16x32_bf16 v[104:107], v[34:37], v[68:71], v[104:107]
    v_mfma_f32_16x16x32_bf16 v[120:123], v[34:37], v[72:75], v[120:123]
    v_mfma_f32_16x16x32_bf16 v[108:111], v[38:41], v[68:71], v[108:111]
    v_mfma_f32_16x16x32_bf16 v[124:127], v[38:41], v[72:75], v[124:127]
    v_mfma_f32_16x16x32_bf16 v[112:115], v[40:43], v[68:71], v[112:115]
    v_mfma_f32_16x16x32_bf16 v[128:131], v[40:43], v[72:75], v[128:131]
    v_mfma_f32_16x16x32_bf16 v[100:103], v[62:65], v[76:79], v[100:103]
    v_mfma_f32_16x16x32_bf16 v[116:119], v[62:65], v[80:83], v[116:119]
    v_mfma_f32_16x16x32_bf16 v[104:107], v[64:67], v[76:79], v[104:107]
    v_mfma_f32_16x16x32_bf16 v[120:123], v[64:67], v[80:83], v[120:123]
    v_mfma_f32_16x16x32_bf16 v[108:111], v[32:35], v[76:79], v[108:111]
    v_mfma_f32_16x16x32_bf16 v[124:127], v[32:35], v[80:83], v[124:127]
    v_mfma_f32_16x16x32_bf16 v[112:115], v[34:37], v[76:79], v[112:115]
    v_mfma_f32_16x16x32_bf16 v[128:131], v[34:37], v[80:83], v[128:131]
    ds_read_b128 v[56:59], v216 offset:1024
    ds_read_b64 v[60:61], v216 offset:1040
    ds_read_b128 v[62:65], v216 offset:1088
    ds_read_b64 v[66:67], v216 offset:1104
    ds_read_b128 v[68:71], v217 offset:128
    ds_read_b128 v[72:75], v217 offset:384
    ds_read_b128 v[76:79], v217 offset:3200
    ds_read_b128 v[80:83], v217 offset:3456
    s_waitcnt lgkmcnt(8)
    v_mfma_f32_16x16x32_bf16 v[100:103], v[44:47], v[84:87], v[100:103]
    v_mfma_f32_16x16x32_bf16 v[116:119], v[44:47], v[88:91], v[116:119]
    v_mfma_f32_16x16x32_bf16 v[104:107], v[46:49], v[84:87], v[104:107]
    v_mfma_f32_16x16x32_bf16 v[120:123], v[46:49], v[88:91], v[120:123]
    v_mfma_f32_16x16x32_bf16 v[108:111], v[50:53], v[84:87], v[108:111]
    v_mfma_f32_16x16x32_bf16 v[124:127], v[50:53], v[88:91], v[124:127]
    v_mfma_f32_16x16x32_bf16 v[112:115], v[52:55], v[84:87], v[112:115]
    v_mfma_f32_16x16x32_bf16 v[128:131], v[52:55], v[88:91], v[128:131]
    v_mfma_f32_16x16x32_bf16 v[100:103], v[38:41], v[92:95], v[100:103]
    v_mfma_f32_16x16x32_bf16 v[116:119], v[38:41], v[96:99], v[116:119]
    v_mfma_f32_16x16x32_bf16 v[104:107], v[40:43], v[92:95], v[104:107]
    v_mfma_f32_16x16x32_bf16 v[120:123], v[40:43], v[96:99], v[120:123]
    v_mfma_f32_16x16x32_bf16 v[108:111], v[44:47], v[92:95], v[108:111]
    v_mfma_f32_16x16x32_bf16 v[124:127], v[44:47], v[96:99], v[124:127]
    v_mfma_f32_16x16x32_bf16 v[112:115], v[46:49], v[92:95], v[112:115]
    v_mfma_f32_16x16x32_bf16 v[128:131], v[46:49], v[96:99], v[128:131]
    ds_read_b128 v[32:35], v216 offset:1152
    ds_read_b64 v[36:37], v216 offset:1168
    ds_read_b128 v[38:41], v216 offset:1216
    ds_read_b64 v[42:43], v216 offset:1232
    ds_read_b128 v[84:87], v217 offset:112
    ds_read_b128 v[88:91], v217 offset:368
    ds_read_b128 v[92:95], v217 offset:3184
    ds_read_b128 v[96:99], v217 offset:3440
    s_waitcnt lgkmcnt(8)
    v_mfma_f32_16x16x32_bf16 v[100:103], v[56:59], v[68:71], v[100:103]
    v_mfma_f32_16x16x32_bf16 v[116:119], v[56:59], v[72:75], v[116:119]
    v_mfma_f32_16x16x32_bf16 v[104:107], v[58:61], v[68:71], v[104:107]
    v_mfma_f32_16x16x32_bf16 v[120:123], v[58:61], v[72:75], v[120:123]
    v_mfma_f32_16x16x32_bf16 v[108:111], v[62:65], v[68:71], v[108:111]
    v_mfma_f32_16x16x32_bf16 v[124:127], v[62:65], v[72:75], v[124:127]
    v_mfma_f32_16x16x32_bf16 v[112:115], v[64:67], v[68:71], v[112:115]
    v_mfma_f32_16x16x32_bf16 v[128:131], v[64:67], v[72:75], v[128:131]
    v_mfma_f32_16x16x32_bf16 v[100:103], v[50:53], v[76:79], v[100:103]
    v_mfma_f32_16x16x32_bf16 v[116:119], v[50:53], v[80:83], v[116:119]
    v_mfma_f32_16x16x32_bf16 v[104:107], v[52:55], v[76:79], v[104:107]
    v_mfma_f32_16x16x32_bf16 v[120:123], v[52:55], v[80:83], v[120:123]
    v_mfma_f32_16x16x32_bf16 v[108:111], v[56:59], v[76:79], v[108:111]
    v_mfma_f32_16x16x32_bf16 v[124:127], v[56:59], v[80:83], v[124:127]
    v_mfma_f32_16x16x32_bf16 v[112:115], v[58:61], v[76:79], v[112:115]
    v_mfma_f32_16x16x32_bf16 v[128:131], v[58:61], v[80:83], v[128:131]
    ds_read_b128 v[44:47], v216 offset:1280
    ds_read_b64 v[48:49], v216 offset:1296
    ds_read_b128 v[50:53], v216 offset:1344
    ds_read_b64 v[54:55], v216 offset:1360
    ds_read_b128 v[68:71], v217 offset:96
    ds_read_b128 v[72:75], v217 offset:352
    ds_read_b128 v[76:79], v217 offset:3168
    ds_read_b128 v[80:83], v217 offset:3424
    s_waitcnt lgkmcnt(8)
    v_mfma_f32_16x16x32_bf16 v[100:103], v[32:35], v[84:87], v[100:103]
    v_mfma_f32_16x16x32_bf16 v[116:119], v[32:35], v[88:91], v[116:119]
    v_mfma_f32_16x16x32_bf16 v[104:107], v[34:37], v[84:87], v[104:107]
    v_mfma_f32_16x16x32_bf16 v[120:123], v[34:37], v[88:91], v[120:123]
    v_mfma_f32_16x16x32_bf16 v[108:111], v[38:41], v[84:87], v[108:111]
    v_mfma_f32_16x16x32_bf16 v[124:127], v[38:41], v[88:91], v[124:127]
    v_mfma_f32_16x16x32_bf16 v[112:115], v[40:43], v[84:87], v[112:115]
    v_mfma_f32_16x16x32_bf16 v[128:131], v[40:43], v[88:91], v[128:131]
    v_mfma_f32_16x16x32_bf16 v[100:103], v[62:65], v[92:95], v[100:103]
    v_mfma_f32_16x16x32_bf16 v[116:119], v[62:65], v[96:99], v[116:119]
    v_mfma_f32_16x16x32_bf16 v[104:107], v[64:67], v[92:95], v[104:107]
    v_mfma_f32_16x16x32_bf16 v[120:123], v[64:67], v[96:99], v[120:123]
    v_mfma_f32_16x16x32_bf16 v[108:111], v[32:35], v[92:95], v[108:111]
    v_mfma_f32_16x16x32_bf16 v[124:127], v[32:35], v[96:99], v[124:127]
    v_mfma_f32_16x16x32_bf16 v[112:115], v[34:37], v[92:95], v[112:115]
    v_mfma_f32_16x16x32_bf16 v[128:131], v[34:37], v[96:99], v[128:131]
    ds_read_b128 v[56:59], v216 offset:1408
    ds_read_b64 v[60:61], v216 offset:1424
    ds_read_b128 v[62:65], v216 offset:1472
    ds_read_b64 v[66:67], v216 offset:1488
    ds_read_b128 v[84:87], v217 offset:80
    ds_read_b128 v[88:91], v217 offset:336
    ds_read_b128 v[92:95], v217 offset:3152
    ds_read_b128 v[96:99], v217 offset:3408
    s_waitcnt lgkmcnt(8)
    v_mfma_f32_16x16x32_bf16 v[100:103], v[44:47], v[68:71], v[100:103]
    v_mfma_f32_16x16x32_bf16 v[116:119], v[44:47], v[72:75], v[116:119]
    v_mfma_f32_16x16x32_bf16 v[104:107], v[46:49], v[68:71], v[104:107]
    v_mfma_f32_16x16x32_bf16 v[120:123], v[46:49], v[72:75], v[120:123]
    v_mfma_f32_16x16x32_bf16 v[108:111], v[50:53], v[68:71], v[108:111]
    v_mfma_f32_16x16x32_bf16 v[124:127], v[50:53], v[72:75], v[124:127]
    v_mfma_f32_16x16x32_bf16 v[112:115], v[52:55], v[68:71], v[112:115]
    v_mfma_f32_16x16x32_bf16 v[128:131], v[52:55], v[72:75], v[128:131]
    v_mfma_f32_16x16x32_bf16 v[100:103], v[38:41], v[76:79], v[100:103]
    v_mfma_f32_16x16x32_bf16 v[116:119], v[38:41], v[80:83], v[116:119]
    v_mfma_f32_16x16x32_bf16 v[104:107], v[40:43], v[76:79], v[104:107]
    v_mfma_f32_16x16x32_bf16 v[120:123], v[40:43], v[80:83], v[120:123]
    v_mfma_f32_16x16x32_bf16 v[108:111], v[44:47], v[76:79], v[108:111]
    v_mfma_f32_16x16x32_bf16 v[124:127], v[44:47], v[80:83], v[124:127]
    v_mfma_f32_16x16x32_bf16 v[112:115], v[46:49], v[76:79], v[112:115]
    v_mfma_f32_16x16x32_bf16 v[128:131], v[46:49], v[80:83], v[128:131]
    s_waitcnt lgkmcnt(0)
    v_mfma_f32_16x16x32_bf16 v[100:103], v[56:59], v[84:87], v[100:103]
    v_mfma_f32_16x16x32_bf16 v[116:119], v[56:59], v[88:91], v[116:119]
    v_mfma_f32_16x16x32_bf16 v[104:107], v[58:61], v[84:87], v[104:107]
    v_mfma_f32_16x16x32_bf16 v[120:123], v[58:61], v[88:91], v[120:123]
    v_mfma_f32_16x16x32_bf16 v[108:111], v[62:65], v[84:87], v[108:111]
    v_mfma_f32_16x16x32_bf16 v[124:127], v[62:65], v[88:91], v[124:127]
    v_mfma_f32_16x16x32_bf16 v[112:115], v[64:67], v[84:87], v[112:115]
    v_mfma_f32_16x16x32_bf16 v[128:131], v[64:67], v[88:91], v[128:131]
    v_mfma_f32_16x16x32_bf16 v[100:103], v[50:53], v[92:95], v[100:103]
    v_mfma_f32_16x16x32_bf16 v[116:119], v[50:53], v[96:99], v[116:119]
    v_mfma_f32_16x16x32_bf16 v[104:107], v[52:55], v[92:95], v[104:107]
    v_mfma_f32_16x16x32_bf16 v[120:123], v[52:55], v[96:99], v[120:123]
    v_mfma_f32_16x16x32_bf16 v[108:111], v[56:59], v[92:95], v[108:111]
    v_mfma_f32_16x16x32_bf16 v[124:127], v[56:59], v[96:99], v[124:127]
    v_mfma_f32_16x16x32_bf16 v[112:115], v[58:61], v[92:95], v[112:115]
    v_mfma_f32_16x16x32_bf16 v[128:131], v[58:61], v[96:99], v[128:131]
    ds_write_b32 v222, v23 offset:8
    ds_read_b128 v[168:171], v218 offset:256
    ds_read_b128 v[172:175], v218 offset:3328
    s_lshl_b32 s7, s20, 12
    s_add_u32 s7, s7, 10485760
    s_lshl_b32 s8, s69, 4
    s_lshr_b32 s23, s23, s8
    s_lshl_b32 s23, s23, 16
    s_lshl_b32 s15, s20, 7
    s_add_u32 s15, s15, 13107200
    s_mov_b32 s42, 0
CD_12:
    ds_read_b32 v6, v222 offset:12
    s_add_u32 s42, s42, 1
    s_cmp_gt_u32 s42, 0x100000
    s_cbranch_scc1 CDOK_13
    s_waitcnt lgkmcnt(0)
    v_cmp_eq_u32 vcc, v23, v6
    s_nop 3
    s_cmp_eq_u64 vcc, exec
    s_cbranch_scc0 CD_12
CDOK_13:
    s_waitcnt lgkmcnt(0)
    ds_write_b128 v220, v[116:119] offset:0
    ds_write_b128 v220, v[120:123] offset:1024
    ds_write_b128 v220, v[124:127] offset:2048
    ds_write_b128 v220, v[128:131] offset:3072
    s_waitcnt lgkmcnt(0)
    ds_write_b32 v222, v23 offset:16
    v_lshlrev_b32 v39, 16, v168
    v_and_b32 v38, 0xffff0000, v168
    v_lshlrev_b32 v37, 16, v169
    v_and_b32 v36, 0xffff0000, v169
    v_lshlrev_b32 v35, 16, v170
    v_and_b32 v34, 0xffff0000, v170
    v_lshlrev_b32 v33, 16, v171
    v_and_b32 v32, 0xffff0000, v171
    v_lshlrev_b32 v47, 16, v172
    v_and_b32 v46, 0xffff0000, v172
    v_lshlrev_b32 v45, 16, v173
    v_and_b32 v44, 0xffff0000, v173
    v_lshlrev_b32 v43, 16, v174
    v_and_b32 v42, 0xffff0000, v174
    v_lshlrev_b32 v41, 16, v175
    v_and_b32 v40, 0xffff0000, v175
    v_mul_f32 v32, s23, v32
    v_mul_f32 v33, s23, v33
    v_mul_f32 v34, s23, v34
    v_mul_f32 v35, s23, v35
    v_mul_f32 v36, s23, v36
    v_mul_f32 v37, s23, v37
    v_mul_f32 v38, s23, v38
    v_mul_f32 v39, s23, v39
    v_mul_f32 v40, s23, v40
    v_mul_f32 v41, s23, v41
    v_mul_f32 v42, s23, v42
    v_mul_f32 v43, s23, v43
    v_mul_f32 v44, s23, v44
    v_mul_f32 v45, s23, v45
    v_mul_f32 v46, s23, v46
    v_mul_f32 v47, s23, v47
    v_cvt_pk_bf16_f32 v33, v32, v33
    v_lshlrev_b32 v32, 16, v33
    v_and_b32 v33, 0xffff0000, v33
    v_cvt_pk_bf16_f32 v35, v34, v35
    v_lshlrev_b32 v34, 16, v35
    v_and_b32 v35, 0xffff0000, v35
    v_cvt_pk_bf16_f32 v37, v36, v37
    v_lshlrev_b32 v36, 16, v37
    v_and_b32 v37, 0xffff0000, v37
    v_cvt_pk_bf16_f32 v39, v38, v39
    v_lshlrev_b32 v38, 16, v39
    v_and_b32 v39, 0xffff0000, v39
    v_cvt_pk_bf16_f32 v41, v40, v41
    v_lshlrev_b32 v40, 16, v41
    v_and_b32 v41, 0xffff0000, v41
    v_cvt_pk_bf16_f32 v43, v42, v43
    v_lshlrev_b32 v42, 16, v43
    v_and_b32 v43, 0xffff0000, v43
    v_cvt_pk_bf16_f32 v45, v44, v45
    v_lshlrev_b32 v44, 16, v45
    v_and_b32 v45, 0xffff0000, v45
    v_cvt_pk_bf16_f32 v47, v46, v47
    v_lshlrev_b32 v46, 16, v47
    v_and_b32 v47, 0xffff0000, v47
    s_mov_b32 s42, 0
CX_14:
    ds_read_b32 v6, v222 offset:20
    s_add_u32 s42, s42, 1
    s_cmp_gt_u32 s42, 0x100000
    s_cbranch_scc1 CXOK_15
    s_waitcnt lgkmcnt(0)
    v_cmp_eq_u32 vcc, v23, v6
    s_nop 3
    s_cmp_eq_u64 vcc, exec
    s_cbranch_scc0 CX_14
CXOK_15:
    s_waitcnt lgkmcnt(0)
    ds_read_b128 v[68:71], v221 offset:0
    ds_read_b128 v[72:75], v221 offset:1024
    ds_read_b128 v[76:79], v221 offset:2048
    ds_read_b128 v[80:83], v221 offset:3072
    s_waitcnt lgkmcnt(0)
    v_pk_add_f32 v[100:101], v[100:101], v[68:69]
    v_pk_add_f32 v[102:103], v[102:103], v[70:71]
    v_pk_add_f32 v[104:105], v[104:105], v[72:73]
    v_pk_add_f32 v[106:107], v[106:107], v[74:75]
    v_pk_add_f32 v[108:109], v[108:109], v[76:77]
    v_pk_add_f32 v[110:111], v[110:111], v[78:79]
    v_pk_add_f32 v[112:113], v[112:113], v[80:81]
    v_pk_add_f32 v[114:115], v[114:115], v[82:83]
    v_cvt_pk_bf16_f32 v101, v100, v101
    v_lshlrev_b32 v100, 16, v101
    v_and_b32 v101, 0xffff0000, v101
    v_cvt_pk_bf16_f32 v103, v102, v103
    v_lshlrev_b32 v102, 16, v103
    v_and_b32 v103, 0xffff0000, v103
    v_cvt_pk_bf16_f32 v105, v104, v105
    v_lshlrev_b32 v104, 16, v105
    v_and_b32 v105, 0xffff0000, v105
    v_cvt_pk_bf16_f32 v107, v106, v107
    v_lshlrev_b32 v106, 16, v107
    v_and_b32 v107, 0xffff0000, v107
    v_cvt_pk_bf16_f32 v109, v108, v109
    v_lshlrev_b32 v108, 16, v109
    v_and_b32 v109, 0xffff0000, v109
    v_cvt_pk_bf16_f32 v111, v110, v111
    v_lshlrev_b32 v110, 16, v111
    v_and_b32 v111, 0xffff0000, v111
    v_cvt_pk_bf16_f32 v113, v112, v113
    v_lshlrev_b32 v112, 16, v113
    v_and_b32 v113, 0xffff0000, v113
    v_cvt_pk_bf16_f32 v115, v114, v115
    v_lshlrev_b32 v114, 16, v115
    v_and_b32 v115, 0xffff0000, v115
    v_pk_add_f32 v[100:101], v[100:101], v[32:33]
    v_pk_add_f32 v[102:103], v[102:103], v[34:35]
    v_pk_add_f32 v[104:105], v[104:105], v[36:37]
    v_pk_add_f32 v[106:107], v[106:107], v[38:39]
    v_pk_add_f32 v[108:109], v[108:109], v[40:41]
    v_pk_add_f32 v[110:111], v[110:111], v[42:43]
    v_pk_add_f32 v[112:113], v[112:113], v[44:45]
    v_pk_add_f32 v[114:115], v[114:115], v[46:47]
    v_cvt_pk_bf16_f32 v84, v100, v101
    v_cvt_pk_bf16_f32 v85, v102, v103
    v_cvt_pk_bf16_f32 v86, v104, v105
    v_cvt_pk_bf16_f32 v87, v106, v107
    v_cvt_pk_bf16_f32 v88, v108, v109
    v_cvt_pk_bf16_f32 v89, v110, v111
    v_cvt_pk_bf16_f32 v90, v112, v113
    v_cvt_pk_bf16_f32 v91, v114, v115
    buffer_store_dwordx4 v[84:87], v219, s[52:55], s7 offen sc1
    buffer_store_dwordx4 v[88:91], v219, s[52:55], s7 offen offset:64 sc1
    s_branch B_FINAL
C_HALF1:
    ds_write_b32 v222, v23 offset:4
    s_mov_b32 s42, 0
CR_16:
    ds_read_b32 v6, v222 offset:0
    s_add_u32 s42, s42, 1
    s_cmp_gt_u32 s42, 0x100000
    s_cbranch_scc1 CROK_17
    s_waitcnt lgkmcnt(0)
    v_cmp_eq_u32 vcc, v23, v6
    s_nop 3
    s_cmp_eq_u64 vcc, exec
    s_cbranch_scc0 CR_16
CROK_17:
    s_waitcnt lgkmcnt(0)
    ds_read_b128 v[62:65], v216 offset:1472
    ds_read_b64 v[66:67], v216 offset:1488
    ds_read_b128 v[32:35], v216 offset:1536
    ds_read_b64 v[36:37], v216 offset:1552
    ds_read_b128 v[38:41], v216 offset:1600
    ds_read_b64 v[42:43], v216 offset:1616
    ds_read_b128 v[68:71], v217 offset:64
    ds_read_b128 v[72:75], v217 offset:320
    ds_read_b128 v[76:79], v217 offset:3136
    ds_read_b128 v[80:83], v217 offset:3392
    ds_read_b128 v[44:47], v216 offset:1664
    ds_read_b64 v[48:49], v216 offset:1680
    ds_read_b128 v[50:53], v216 offset:1728
    ds_read_b64 v[54:55], v216 offset:1744
    ds_read_b128 v[84:87], v217 offset:48
    ds_read_b128 v[88:91], v217 offset:304
    ds_read_b128 v[92:95], v217 offset:3120
    ds_read_b128 v[96:99], v217 offset:3376
    s_waitcnt lgkmcnt(8)
    v_mfma_f32_16x16x32_bf16 v[100:103], v[32:35], v[68:71], 0
    v_mfma_f32_16x16x32_bf16 v[116:119], v[32:35], v[72:75], 0
    v_mfma_f32_16x16x32_bf16 v[104:107], v[34:37], v[68:71], 0
    v_mfma_f32_16x16x32_bf16 v[120:123], v[34:37], v[72:75], 0
    v_mfma_f32_16x16x32_bf16 v[108:111], v[38:41], v[68:71], 0
    v_mfma_f32_16x16x32_bf16 v[124:127], v[38:41], v[72:75], 0
    v_mfma_f32_16x16x32_bf16 v[112:115], v[40:43], v[68:71], 0
    v_mfma_f32_16x16x32_bf16 v[128:131], v[40:43], v[72:75], 0
    v_mfma_f32_16x16x32_bf16 v[100:103], v[62:65], v[76:79], v[100:103]
    v_mfma_f32_16x16x32_bf16 v[116:119], v[62:65], v[80:83], v[116:119]
    v_mfma_f32_16x16x32_bf16 v[104:107], v[64:67], v[76:79], v[104:107]
    v_mfma_f32_16x16x32_bf16 v[120:123], v[64:67], v[80:83], v[120:123]
    v_mfma_f32_16x16x32_bf16 v[108:111], v[32:35], v[76:79], v[108:111]
    v_mfma_f32_16x16x32_bf16 v[124:127], v[32:35], v[80:83], v[124:127]
    v_mfma_f32_16x16x32_bf16 v[112:115], v[34:37], v[76:79], v[112:115]
    v_mfma_f32_16x16x32_bf16 v[128:131], v[34:37], v[80:83], v[128:131]
    ds_read_b128 v[56:59], v216 offset:1792
    ds_read_b64 v[60:61], v216 offset:1808
    ds_read_b128 v[62:65], v216 offset:1856
    ds_read_b64 v[66:67], v216 offset:1872
    ds_read_b128 v[68:71], v217 offset:32
    ds_read_b128 v[72:75], v217 offset:288
    ds_read_b128 v[76:79], v217 offset:3104
    ds_read_b128 v[80:83], v217 offset:3360
    s_waitcnt lgkmcnt(8)
    v_mfma_f32_16x16x32_bf16 v[100:103], v[44:47], v[84:87], v[100:103]
    v_mfma_f32_16x16x32_bf16 v[116:119], v[44:47], v[88:91], v[116:119]
    v_mfma_f32_16x16x32_bf16 v[104:107], v[46:49], v[84:87], v[104:107]
    v_mfma_f32_16x16x32_bf16 v[120:123], v[46:49], v[88:91], v[120:123]
    v_mfma_f32_16x16x32_bf16 v[108:111], v[50:53], v[84:87], v[108:111]
    v_mfma_f32_16x16x32_bf16 v[124:127], v[50:53], v[88:91], v[124:127]
    v_mfma_f32_16x16x32_bf16 v[112:115], v[52:55], v[84:87], v[112:115]
    v_mfma_f32_16x16x32_bf16 v[128:131], v[52:55], v[88:91], v[128:131]
    v_mfma_f32_16x16x32_bf16 v[100:103], v[38:41], v[92:95], v[100:103]
    v_mfma_f32_16x16x32_bf16 v[116:119], v[38:41], v[96:99], v[116:119]
    v_mfma_f32_16x16x32_bf16 v[104:107], v[40:43], v[92:95], v[104:107]
    v_mfma_f32_16x16x32_bf16 v[120:123], v[40:43], v[96:99], v[120:123]
    v_mfma_f32_16x16x32_bf16 v[108:111], v[44:47], v[92:95], v[108:111]
    v_mfma_f32_16x16x32_bf16 v[124:127], v[44:47], v[96:99], v[124:127]
    v_mfma_f32_16x16x32_bf16 v[112:115], v[46:49], v[92:95], v[112:115]
    v_mfma_f32_16x16x32_bf16 v[128:131], v[46:49], v[96:99], v[128:131]
    ds_read_b128 v[32:35], v216 offset:1920
    ds_read_b64 v[36:37], v216 offset:1936
    ds_read_b128 v[38:41], v216 offset:1984
    ds_read_b64 v[42:43], v216 offset:2000
    ds_read_b128 v[84:87], v217 offset:16
    ds_read_b128 v[88:91], v217 offset:272
    ds_read_b128 v[92:95], v217 offset:3088
    ds_read_b128 v[96:99], v217 offset:3344
    s_waitcnt lgkmcnt(8)
    v_mfma_f32_16x16x32_bf16 v[100:103], v[56:59], v[68:71], v[100:103]
    v_mfma_f32_16x16x32_bf16 v[116:119], v[56:59], v[72:75], v[116:119]
    v_mfma_f32_16x16x32_bf16 v[104:107], v[58:61], v[68:71], v[104:107]
    v_mfma_f32_16x16x32_bf16 v[120:123], v[58:61], v[72:75], v[120:123]
    v_mfma_f32_16x16x32_bf16 v[108:111], v[62:65], v[68:71], v[108:111]
    v_mfma_f32_16x16x32_bf16 v[124:127], v[62:65], v[72:75], v[124:127]
    v_mfma_f32_16x16x32_bf16 v[112:115], v[64:67], v[68:71], v[112:115]
    v_mfma_f32_16x16x32_bf16 v[128:131], v[64:67], v[72:75], v[128:131]
    v_mfma_f32_16x16x32_bf16 v[100:103], v[50:53], v[76:79], v[100:103]
    v_mfma_f32_16x16x32_bf16 v[116:119], v[50:53], v[80:83], v[116:119]
    v_mfma_f32_16x16x32_bf16 v[104:107], v[52:55], v[76:79], v[104:107]
    v_mfma_f32_16x16x32_bf16 v[120:123], v[52:55], v[80:83], v[120:123]
    v_mfma_f32_16x16x32_bf16 v[108:111], v[56:59], v[76:79], v[108:111]
    v_mfma_f32_16x16x32_bf16 v[124:127], v[56:59], v[80:83], v[124:127]
    v_mfma_f32_16x16x32_bf16 v[112:115], v[58:61], v[76:79], v[112:115]
    v_mfma_f32_16x16x32_bf16 v[128:131], v[58:61], v[80:83], v[128:131]
    ds_read_b128 v[44:47], v216 offset:2048
    ds_read_b64 v[48:49], v216 offset:2064
    ds_read_b128 v[50:53], v216 offset:2112
    ds_read_b64 v[54:55], v216 offset:2128
    ds_read_b128 v[72:75], v217 offset:256
    ds_read_b128 v[80:83], v217 offset:3328
    s_waitcnt lgkmcnt(6)
    v_mfma_f32_16x16x32_bf16 v[100:103], v[32:35], v[84:87], v[100:103]
    v_mfma_f32_16x16x32_bf16 v[116:119], v[32:35], v[88:91], v[116:119]
    v_mfma_f32_16x16x32_bf16 v[104:107], v[34:37], v[84:87], v[104:107]
    v_mfma_f32_16x16x32_bf16 v[120:123], v[34:37], v[88:91], v[120:123]
    v_mfma_f32_16x16x32_bf16 v[108:111], v[38:41], v[84:87], v[108:111]
    v_mfma_f32_16x16x32_bf16 v[124:127], v[38:41], v[88:91], v[124:127]
    v_mfma_f32_16x16x32_bf16 v[112:115], v[40:43], v[84:87], v[112:115]
    v_mfma_f32_16x16x32_bf16 v[128:131], v[40:43], v[88:91], v[128:131]
    v_mfma_f32_16x16x32_bf16 v[100:103], v[62:65], v[92:95], v[100:103]
    v_mfma_f32_16x16x32_bf16 v[116:119], v[62:65], v[96:99], v[116:119]
    v_mfma_f32_16x16x32_bf16 v[104:107], v[64:67], v[92:95], v[104:107]
    v_mfma_f32_16x16x32_bf16 v[120:123], v[64:67], v[96:99], v[120:123]
    v_mfma_f32_16x16x32_bf16 v[108:111], v[32:35], v[92:95], v[108:111]
    v_mfma_f32_16x16x32_bf16 v[124:127], v[32:35], v[96:99], v[124:127]
    v_mfma_f32_16x16x32_bf16 v[112:115], v[34:37], v[92:95], v[112:115]
    v_mfma_f32_16x16x32_bf16 v[128:131], v[34:37], v[96:99], v[128:131]
    ds_read_b128 v[56:59], v216 offset:2176
    ds_read_b64 v[60:61], v216 offset:2192
    ds_read_b128 v[62:65], v216 offset:2240
    ds_read_b64 v[66:67], v216 offset:2256
    ds_read_b128 v[88:91], v217 offset:240
    ds_read_b128 v[96:99], v217 offset:3312
    s_waitcnt lgkmcnt(6)
    v_mfma_f32_16x16x32_bf16 v[116:119], v[44:47], v[72:75], v[116:119]
    v_mfma_f32_16x16x32_bf16 v[120:123], v[46:49], v[72:75], v[120:123]
    v_mfma_f32_16x16x32_bf16 v[124:127], v[50:53], v[72:75], v[124:127]
    v_mfma_f32_16x16x32_bf16 v[128:131], v[52:55], v[72:75], v[128:131]
    v_mfma_f32_16x16x32_bf16 v[116:119], v[38:41], v[80:83], v[116:119]
    v_mfma_f32_16x16x32_bf16 v[120:123], v[40:43], v[80:83], v[120:123]
    v_mfma_f32_16x16x32_bf16 v[124:127], v[44:47], v[80:83], v[124:127]
    v_mfma_f32_16x16x32_bf16 v[128:131], v[46:49], v[80:83], v[128:131]
    ds_read_b128 v[32:35], v216 offset:2304
    ds_read_b64 v[36:37], v216 offset:2320
    ds_read_b128 v[38:41], v216 offset:2368
    ds_read_b64 v[42:43], v216 offset:2384
    ds_read_b128 v[72:75], v217 offset:224
    ds_read_b128 v[80:83], v217 offset:3296
    s_waitcnt lgkmcnt(6)
    v_mfma_f32_16x16x32_bf16 v[116:119], v[56:59], v[88:91], v[116:119]
    v_mfma_f32_16x16x32_bf16 v[120:123], v[58:61], v[88:91], v[120:123]
    v_mfma_f32_16x16x32_bf16 v[124:127], v[62:65], v[88:91], v[124:127]
    v_mfma_f32_16x16x32_bf16 v[128:131], v[64:67], v[88:91], v[128:131]
    v_mfma_f32_16x16x32_bf16 v[116:119], v[50:53], v[96:99], v[116:119]
    v_mfma_f32_16x16x32_bf16 v[120:123], v[52:55], v[96:99], v[120:123]
    v_mfma_f32_16x16x32_bf16 v[124:127], v[56:59], v[96:99], v[124:127]
    v_mfma_f32_16x16x32_bf16 v[128:131], v[58:61], v[96:99], v[128:131]
    ds_read_b128 v[44:47], v216 offset:2432
    ds_read_b64 v[48:49], v216 offset:2448
    ds_read_b128 v[50:53], v216 offset:2496
    ds_read_b64 v[54:55], v216 offset:2512
    ds_read_b128 v[88:91], v217 offset:208
    ds_read_b128 v[96:99], v217 offset:3280
    s_waitcnt lgkmcnt(6)
    v_mfma_f32_16x16x32_bf16 v[116:119], v[32:35], v[72:75], v[116:119]
    v_mfma_f32_16x16x32_bf16 v[120:123], v[34:37], v[72:75], v[120:123]
    v_mfma_f32_16x16x32_bf16 v[124:127], v[38:41], v[72:75], v[124:127]
    v_mfma_f32_16x16x32_bf16 v[128:131], v[40:43], v[72:75], v[128:131]
    v_mfma_f32_16x16x32_bf16 v[116:119], v[62:65], v[80:83], v[116:119]
    v_mfma_f32_16x16x32_bf16 v[120:123], v[64:67], v[80:83], v[120:123]
    v_mfma_f32_16x16x32_bf16 v[124:127], v[32:35], v[80:83], v[124:127]
    v_mfma_f32_16x16x32_bf16 v[128:131], v[34:37], v[80:83], v[128:131]
    ds_read_b128 v[56:59], v216 offset:2560
    ds_read_b64 v[60:61], v216 offset:2576
    ds_read_b128 v[62:65], v216 offset:2624
    ds_read_b64 v[66:67], v216 offset:2640
    ds_read_b128 v[72:75], v217 offset:192
    ds_read_b128 v[80:83], v217 offset:3264
    s_waitcnt lgkmcnt(6)
    v_mfma_f32_16x16x32_bf16 v[116:119], v[44:47], v[88:91], v[116:119]
    v_mfma_f32_16x16x32_bf16 v[120:123], v[46:49], v[88:91], v[120:123]
    v_mfma_f32_16x16x32_bf16 v[124:127], v[50:53], v[88:91], v[124:127]
    v_mfma_f32_16x16x32_bf16 v[128:131], v[52:55], v[88:91], v[128:131]
    v_mfma_f32_16x16x32_bf16 v[116:119], v[38:41], v[96:99], v[116:119]
    v_mfma_f32_16x16x32_bf16 v[120:123], v[40:43], v[96:99], v[120:123]
    v_mfma_f32_16x16x32_bf16 v[124:127], v[44:47], v[96:99], v[124:127]
    v_mfma_f32_16x16x32_bf16 v[128:131], v[46:49], v[96:99], v[128:131]
    ds_read_b128 v[32:35], v216 offset:2688
    ds_read_b64 v[36:37], v216 offset:2704
    ds_read_b128 v[38:41], v216 offset:2752
    ds_read_b64 v[42:43], v216 offset:2768
    ds_read_b128 v[88:91], v217 offset:176
    ds_read_b128 v[96:99], v217 offset:3248
    s_waitcnt lgkmcnt(6)
    v_mfma_f32_16x16x32_bf16 v[116:119], v[56:59], v[72:75], v[116:119]
    v_mfma_f32_16x16x32_bf16 v[120:123], v[58:61], v[72:75], v[120:123]
    v_mfma_f32_16x16x32_bf16 v[124:127], v[62:65], v[72:75], v[124:127]
    v_mfma_f32_16x16x32_bf16 v[128:131], v[64:67], v[72:75], v[128:131]
    v_mfma_f32_16x16x32_bf16 v[116:119], v[50:53], v[80:83], v[116:119]
    v_mfma_f32_16x16x32_bf16 v[120:123], v[52:55], v[80:83], v[120:123]
    v_mfma_f32_16x16x32_bf16 v[124:127], v[56:59], v[80:83], v[124:127]
    v_mfma_f32_16x16x32_bf16 v[128:131], v[58:61], v[80:83], v[128:131]
    ds_read_b128 v[44:47], v216 offset:2816
    ds_read_b64 v[48:49], v216 offset:2832
    ds_read_b128 v[50:53], v216 offset:2880
    ds_read_b64 v[54:55], v216 offset:2896
    ds_read_b128 v[72:75], v217 offset:160
    ds_read_b128 v[80:83], v217 offset:3232
    s_waitcnt lgkmcnt(6)
    v_mfma_f32_16x16x32_bf16 v[116:119], v[32:35], v[88:91], v[116:119]
    v_mfma_f32_16x16x32_bf16 v[120:123], v[34:37], v[88:91], v[120:123]
    v_mfma_f32_16x16x32_bf16 v[124:127], v[38:41], v[88:91], v[124:127]
    v_mfma_f32_16x16x32_bf16 v[128:131], v[40:43], v[88:91], v[128:131]
    v_mfma_f32_16x16x32_bf16 v[116:119], v[62:65], v[96:99], v[116:119]
    v_mfma_f32_16x16x32_bf16 v[120:123], v[64:67], v[96:99], v[120:123]
    v_mfma_f32_16x16x32_bf16 v[124:127], v[32:35], v[96:99], v[124:127]
    v_mfma_f32_16x16x32_bf16 v[128:131], v[34:37], v[96:99], v[128:131]
    ds_read_b128 v[56:59], v216 offset:2944
    ds_read_b64 v[60:61], v216 offset:2960
    ds_read_b128 v[62:65], v216 offset:3008
    ds_read_b64 v[66:67], v216 offset:3024
    ds_read_b128 v[88:91], v217 offset:144
    ds_read_b128 v[96:99], v217 offset:3216
    s_waitcnt lgkmcnt(6)
    v_mfma_f32_16x16x32_bf16 v[116:119], v[44:47], v[72:75], v[116:119]
    v_mfma_f32_16x16x32_bf16 v[120:123], v[46:49], v[72:75], v[120:123]
    v_mfma_f32_16x16x32_bf16 v[124:127], v[50:53], v[72:75], v[124:127]
    v_mfma_f32_16x16x32_bf16 v[128:131], v[52:55], v[72:75], v[128:131]
    v_mfma_f32_16x16x32_bf16 v[116:119], v[38:41], v[80:83], v[116:119]
    v_mfma_f32_16x16x32_bf16 v[120:123], v[40:43], v[80:83], v[120:123]
    v_mfma_f32_16x16x32_bf16 v[124:127], v[44:47], v[80:83], v[124:127]
    v_mfma_f32_16x16x32_bf16 v[128:131], v[46:49], v[80:83], v[128:131]
    ds_read_b128 v[32:35], v216 offset:3072
    ds_read_b64 v[36:37], v216 offset:3088
    ds_read_b128 v[38:41], v216 offset:3136
    ds_read_b64 v[42:43], v216 offset:3152
    ds_read_b128 v[72:75], v217 offset:128
    ds_read_b128 v[80:83], v217 offset:3200
    s_waitcnt lgkmcnt(6)
    v_mfma_f32_16x16x32_bf16 v[116:119], v[56:59], v[88:91], v[116:119]
    v_mfma_f32_16x16x32_bf16 v[120:123], v[58:61], v[88:91], v[120:123]
    v_mfma_f32_16x16x32_bf16 v[124:127], v[62:65], v[88:91], v[124:127]
    v_mfma_f32_16x16x32_bf16 v[128:131], v[64:67], v[88:91], v[128:131]
    v_mfma_f32_16x16x32_bf16 v[116:119], v[50:53], v[96:99], v[116:119]
    v_mfma_f32_16x16x32_bf16 v[120:123], v[52:55], v[96:99], v[120:123]
    v_mfma_f32_16x16x32_bf16 v[124:127], v[56:59], v[96:99], v[124:127]
    v_mfma_f32_16x16x32_bf16 v[128:131], v[58:61], v[96:99], v[128:131]
    ds_read_b128 v[44:47], v216 offset:3200
    ds_read_b64 v[48:49], v216 offset:3216
    ds_read_b128 v[50:53], v216 offset:3264
    ds_read_b64 v[54:55], v216 offset:3280
    ds_read_b128 v[88:91], v217 offset:112
    ds_read_b128 v[96:99], v217 offset:3184
    s_waitcnt lgkmcnt(6)
    v_mfma_f32_16x16x32_bf16 v[116:119], v[32:35], v[72:75], v[116:119]
    v_mfma_f32_16x16x32_bf16 v[120:123], v[34:37], v[72:75], v[120:123]
    v_mfma_f32_16x16x32_bf16 v[124:127], v[38:41], v[72:75], v[124:127]
    v_mfma_f32_16x16x32_bf16 v[128:131], v[40:43], v[72:75], v[128:131]
    v_mfma_f32_16x16x32_bf16 v[116:119], v[62:65], v[80:83], v[116:119]
    v_mfma_f32_16x16x32_bf16 v[120:123], v[64:67], v[80:83], v[120:123]
    v_mfma_f32_16x16x32_bf16 v[124:127], v[32:35], v[80:83], v[124:127]
    v_mfma_f32_16x16x32_bf16 v[128:131], v[34:37], v[80:83], v[128:131]
    ds_read_b128 v[56:59], v216 offset:3328
    ds_read_b64 v[60:61], v216 offset:3344
    ds_read_b128 v[62:65], v216 offset:3392
    ds_read_b64 v[66:67], v216 offset:3408
    ds_read_b128 v[72:75], v217 offset:96
    ds_read_b128 v[80:83], v217 offset:3168
    s_waitcnt lgkmcnt(6)
    v_mfma_f32_16x16x32_bf16 v[116:119], v[44:47], v[88:91], v[116:119]
    v_mfma_f32_16x16x32_bf16 v[120:123], v[46:49], v[88:91], v[120:123]
    v_mfma_f32_16x16x32_bf16 v[124:127], v[50:53], v[88:91], v[124:127]
    v_mfma_f32_16x16x32_bf16 v[128:131], v[52:55], v[88:91], v[128:131]
    v_mfma_f32_16x16x32_bf16 v[116:119], v[38:41], v[96:99], v[116:119]
    v_mfma_f32_16x16x32_bf16 v[120:123], v[40:43], v[96:99], v[120:123]
    v_mfma_f32_16x16x32_bf16 v[124:127], v[44:47], v[96:99], v[124:127]
    v_mfma_f32_16x16x32_bf16 v[128:131], v[46:49], v[96:99], v[128:131]
    ds_read_b128 v[32:35], v216 offset:3456
    ds_read_b64 v[36:37], v216 offset:3472
    ds_read_b128 v[38:41], v216 offset:3520
    ds_read_b64 v[42:43], v216 offset:3536
    ds_read_b128 v[88:91], v217 offset:80
    ds_read_b128 v[96:99], v217 offset:3152
    s_waitcnt lgkmcnt(6)
    v_mfma_f32_16x16x32_bf16 v[116:119], v[56:59], v[72:75], v[116:119]
    v_mfma_f32_16x16x32_bf16 v[120:123], v[58:61], v[72:75], v[120:123]
    v_mfma_f32_16x16x32_bf16 v[124:127], v[62:65], v[72:75], v[124:127]
    v_mfma_f32_16x16x32_bf16 v[128:131], v[64:67], v[72:75], v[128:131]
    v_mfma_f32_16x16x32_bf16 v[116:119], v[50:53], v[80:83], v[116:119]
    v_mfma_f32_16x16x32_bf16 v[120:123], v[52:55], v[80:83], v[120:123]
    v_mfma_f32_16x16x32_bf16 v[124:127], v[56:59], v[80:83], v[124:127]
    v_mfma_f32_16x16x32_bf16 v[128:131], v[58:61], v[80:83], v[128:131]
    ds_read_b128 v[44:47], v216 offset:3584
    ds_read_b64 v[48:49], v216 offset:3600
    ds_read_b128 v[50:53], v216 offset:3648
    ds_read_b64 v[54:55], v216 offset:3664
    ds_read_b128 v[72:75], v217 offset:64
    ds_read_b128 v[80:83], v217 offset:3136
    s_waitcnt lgkmcnt(6)
    v_mfma_f32_16x16x32_bf16 v[116:119], v[32:35], v[88:91], v[116:119]
    v_mfma_f32_16x16x32_bf16 v[120:123], v[34:37], v[88:91], v[120:123]
    v_mfma_f32_16x16x32_bf16 v[124:127], v[38:41], v[88:91], v[124:127]
    v_mfma_f32_16x16x32_bf16 v[128:131], v[40:43], v[88:91], v[128:131]
    v_mfma_f32_16x16x32_bf16 v[116:119], v[62:65], v[96:99], v[116:119]
    v_mfma_f32_16x16x32_bf16 v[120:123], v[64:67], v[96:99], v[120:123]
    v_mfma_f32_16x16x32_bf16 v[124:127], v[32:35], v[96:99], v[124:127]
    v_mfma_f32_16x16x32_bf16 v[128:131], v[34:37], v[96:99], v[128:131]
    ds_read_b128 v[56:59], v216 offset:3712
    ds_read_b64 v[60:61], v216 offset:3728
    ds_read_b128 v[62:65], v216 offset:3776
    ds_read_b64 v[66:67], v216 offset:3792
    ds_read_b128 v[88:91], v217 offset:48
    ds_read_b128 v[96:99], v217 offset:3120
    s_waitcnt lgkmcnt(6)
    v_mfma_f32_16x16x32_bf16 v[116:119], v[44:47], v[72:75], v[116:119]
    v_mfma_f32_16x16x32_bf16 v[120:123], v[46:49], v[72:75], v[120:123]
    v_mfma_f32_16x16x32_bf16 v[124:127], v[50:53], v[72:75], v[124:127]
    v_mfma_f32_16x16x32_bf16 v[128:131], v[52:55], v[72:75], v[128:131]
    v_mfma_f32_16x16x32_bf16 v[116:119], v[38:41], v[80:83], v[116:119]
    v_mfma_f32_16x16x32_bf16 v[120:123], v[40:43], v[80:83], v[120:123]
    v_mfma_f32_16x16x32_bf16 v[124:127], v[44:47], v[80:83], v[124:127]
    v_mfma_f32_16x16x32_bf16 v[128:131], v[46:49], v[80:83], v[128:131]
    ds_read_b128 v[32:35], v216 offset:3840
    ds_read_b64 v[36:37], v216 offset:3856
    ds_read_b128 v[38:41], v216 offset:3904
    ds_read_b64 v[42:43], v216 offset:3920
    ds_read_b128 v[72:75], v217 offset:32
    ds_read_b128 v[80:83], v217 offset:3104
    s_waitcnt lgkmcnt(6)
    v_mfma_f32_16x16x32_bf16 v[116:119], v[56:59], v[88:91], v[116:119]
    v_mfma_f32_16x16x32_bf16 v[120:123], v[58:61], v[88:91], v[120:123]
    v_mfma_f32_16x16x32_bf16 v[124:127], v[62:65], v[88:91], v[124:127]
    v_mfma_f32_16x16x32_bf16 v[128:131], v[64:67], v[88:91], v[128:131]
    v_mfma_f32_16x16x32_bf16 v[116:119], v[50:53], v[96:99], v[116:119]
    v_mfma_f32_16x16x32_bf16 v[120:123], v[52:55], v[96:99], v[120:123]
    v_mfma_f32_16x16x32_bf16 v[124:127], v[56:59], v[96:99], v[124:127]
    v_mfma_f32_16x16x32_bf16 v[128:131], v[58:61], v[96:99], v[128:131]
    ds_read_b128 v[44:47], v216 offset:3968
    ds_read_b64 v[48:49], v216 offset:3984
    ds_read_b128 v[50:53], v216 offset:4032
    ds_read_b64 v[54:55], v216 offset:4048
    ds_read_b128 v[88:91], v217 offset:16
    ds_read_b128 v[96:99], v217 offset:3088
    s_waitcnt lgkmcnt(6)
    v_mfma_f32_16x16x32_bf16 v[116:119], v[32:35], v[72:75], v[116:119]
    v_mfma_f32_16x16x32_bf16 v[120:123], v[34:37], v[72:75], v[120:123]
    v_mfma_f32_16x16x32_bf16 v[124:127], v[38:41], v[72:75], v[124:127]
    v_mfma_f32_16x16x32_bf16 v[128:131], v[40:43], v[72:75], v[128:131]
    v_mfma_f32_16x16x32_bf16 v[116:119], v[62:65], v[80:83], v[116:119]
    v_mfma_f32_16x16x32_bf16 v[120:123], v[64:67], v[80:83], v[120:123]
    v_mfma_f32_16x16x32_bf16 v[124:127], v[32:35], v[80:83], v[124:127]
    v_mfma_f32_16x16x32_bf16 v[128:131], v[34:37], v[80:83], v[128:131]
    s_waitcnt lgkmcnt(0)
    v_mfma_f32_16x16x32_bf16 v[116:119], v[44:47], v[88:91], v[116:119]
    v_mfma_f32_16x16x32_bf16 v[120:123], v[46:49], v[88:91], v[120:123]
    v_mfma_f32_16x16x32_bf16 v[124:127], v[50:53], v[88:91], v[124:127]
    v_mfma_f32_16x16x32_bf16 v[128:131], v[52:55], v[88:91], v[128:131]
    v_mfma_f32_16x16x32_bf16 v[116:119], v[38:41], v[96:99], v[116:119]
    v_mfma_f32_16x16x32_bf16 v[120:123], v[40:43], v[96:99], v[120:123]
    v_mfma_f32_16x16x32_bf16 v[124:127], v[44:47], v[96:99], v[124:127]
    v_mfma_f32_16x16x32_bf16 v[128:131], v[46:49], v[96:99], v[128:131]
    ds_write_b32 v222, v23 offset:12
    ds_read_b128 v[168:171], v218 offset:512
    ds_read_b128 v[172:175], v218 offset:3584
    s_lshl_b32 s7, s20, 12
    s_add_u32 s7, s7, 10487808
    s_lshl_b32 s8, s69, 4
    s_lshr_b32 s23, s23, s8
    s_lshl_b32 s23, s23, 16
    s_lshl_b32 s15, s20, 7
    s_add_u32 s15, s15, 13164544
    s_mov_b32 s42, 0
CD_18:
    ds_read_b32 v6, v222 offset:8
    s_add_u32 s42, s42, 1
    s_cmp_gt_u32 s42, 0x100000
    s_cbranch_scc1 CDOK_19
    s_waitcnt lgkmcnt(0)
    v_cmp_eq_u32 vcc, v23, v6
    s_nop 3
    s_cmp_eq_u64 vcc, exec
    s_cbranch_scc0 CD_18
CDOK_19:
    s_waitcnt lgkmcnt(0)
    ds_write_b128 v220, v[100:103] offset:0
    ds_write_b128 v220, v[104:107] offset:1024
    ds_write_b128 v220, v[108:111] offset:2048
    ds_write_b128 v220, v[112:115] offset:3072
    s_waitcnt lgkmcnt(0)
    ds_write_b32 v222, v23 offset:20
    v_lshlrev_b32 v39, 16, v168
    v_and_b32 v38, 0xffff0000, v168
    v_lshlrev_b32 v37, 16, v169
    v_and_b32 v36, 0xffff0000, v169
    v_lshlrev_b32 v35, 16, v170
    v_and_b32 v34, 0xffff0000, v170
    v_lshlrev_b32 v33, 16, v171
    v_and_b32 v32, 0xffff0000, v171
    v_lshlrev_b32 v47, 16, v172
    v_and_b32 v46, 0xffff0000, v172
    v_lshlrev_b32 v45, 16, v173
    v_and_b32 v44, 0xffff0000, v173
    v_lshlrev_b32 v43, 16, v174
    v_and_b32 v42, 0xffff0000, v174
    v_lshlrev_b32 v41, 16, v175
    v_and_b32 v40, 0xffff0000, v175
    v_mul_f32 v32, s23, v32
    v_mul_f32 v33, s23, v33
    v_mul_f32 v34, s23, v34
    v_mul_f32 v35, s23, v35
    v_mul_f32 v36, s23, v36
    v_mul_f32 v37, s23, v37
    v_mul_f32 v38, s23, v38
    v_mul_f32 v39, s23, v39
    v_mul_f32 v40, s23, v40
    v_mul_f32 v41, s23, v41
    v_mul_f32 v42, s23, v42
    v_mul_f32 v43, s23, v43
    v_mul_f32 v44, s23, v44
    v_mul_f32 v45, s23, v45
    v_mul_f32 v46, s23, v46
    v_mul_f32 v47, s23, v47
    v_cvt_pk_bf16_f32 v33, v32, v33
    v_lshlrev_b32 v32, 16, v33
    v_and_b32 v33, 0xffff0000, v33
    v_cvt_pk_bf16_f32 v35, v34, v35
    v_lshlrev_b32 v34, 16, v35
    v_and_b32 v35, 0xffff0000, v35
    v_cvt_pk_bf16_f32 v37, v36, v37
    v_lshlrev_b32 v36, 16, v37
    v_and_b32 v37, 0xffff0000, v37
    v_cvt_pk_bf16_f32 v39, v38, v39
    v_lshlrev_b32 v38, 16, v39
    v_and_b32 v39, 0xffff0000, v39
    v_cvt_pk_bf16_f32 v41, v40, v41
    v_lshlrev_b32 v40, 16, v41
    v_and_b32 v41, 0xffff0000, v41
    v_cvt_pk_bf16_f32 v43, v42, v43
    v_lshlrev_b32 v42, 16, v43
    v_and_b32 v43, 0xffff0000, v43
    v_cvt_pk_bf16_f32 v45, v44, v45
    v_lshlrev_b32 v44, 16, v45
    v_and_b32 v45, 0xffff0000, v45
    v_cvt_pk_bf16_f32 v47, v46, v47
    v_lshlrev_b32 v46, 16, v47
    v_and_b32 v47, 0xffff0000, v47
    s_mov_b32 s42, 0
CX_20:
    ds_read_b32 v6, v222 offset:16
    s_add_u32 s42, s42, 1
    s_cmp_gt_u32 s42, 0x100000
    s_cbranch_scc1 CXOK_21
    s_waitcnt lgkmcnt(0)
    v_cmp_eq_u32 vcc, v23, v6
    s_nop 3
    s_cmp_eq_u64 vcc, exec
    s_cbranch_scc0 CX_20
CXOK_21:
    s_waitcnt lgkmcnt(0)
    ds_read_b128 v[68:71], v221 offset:0
    ds_read_b128 v[72:75], v221 offset:1024
    ds_read_b128 v[76:79], v221 offset:2048
    ds_read_b128 v[80:83], v221 offset:3072
    s_waitcnt lgkmcnt(0)
    v_pk_add_f32 v[116:117], v[116:117], v[68:69]
    v_pk_add_f32 v[118:119], v[118:119], v[70:71]
    v_pk_add_f32 v[120:121], v[120:121], v[72:73]
    v_pk_add_f32 v[122:123], v[122:123], v[74:75]
    v_pk_add_f32 v[124:125], v[124:125], v[76:77]
    v_pk_add_f32 v[126:127], v[126:127], v[78:79]
    v_pk_add_f32 v[128:129], v[128:129], v[80:81]
    v_pk_add_f32 v[130:131], v[130:131], v[82:83]
    v_cvt_pk_bf16_f32 v117, v116, v117
    v_lshlrev_b32 v116, 16, v117
    v_and_b32 v117, 0xffff0000, v117
    v_cvt_pk_bf16_f32 v119, v118, v119
    v_lshlrev_b32 v118, 16, v119
    v_and_b32 v119, 0xffff0000, v119
    v_cvt_pk_bf16_f32 v121, v120, v121
    v_lshlrev_b32 v120, 16, v121
    v_and_b32 v121, 0xffff0000, v121
    v_cvt_pk_bf16_f32 v123, v122, v123
    v_lshlrev_b32 v122, 16, v123
    v_and_b32 v123, 0xffff0000, v123
    v_cvt_pk_bf16_f32 v125, v124, v125
    v_lshlrev_b32 v124, 16, v125
    v_and_b32 v125, 0xffff0000, v125
    v_cvt_pk_bf16_f32 v127, v126, v127
    v_lshlrev_b32 v126, 16, v127
    v_and_b32 v127, 0xffff0000, v127
    v_cvt_pk_bf16_f32 v129, v128, v129
    v_lshlrev_b32 v128, 16, v129
    v_and_b32 v129, 0xffff0000, v129
    v_cvt_pk_bf16_f32 v131, v130, v131
    v_lshlrev_b32 v130, 16, v131
    v_and_b32 v131, 0xffff0000, v131
    v_pk_add_f32 v[116:117], v[116:117], v[32:33]
    v_pk_add_f32 v[118:119], v[118:119], v[34:35]
    v_pk_add_f32 v[120:121], v[120:121], v[36:37]
    v_pk_add_f32 v[122:123], v[122:123], v[38:39]
    v_pk_add_f32 v[124:125], v[124:125], v[40:41]
    v_pk_add_f32 v[126:127], v[126:127], v[42:43]
    v_pk_add_f32 v[128:129], v[128:129], v[44:45]
    v_pk_add_f32 v[130:131], v[130:131], v[46:47]
    v_cvt_pk_bf16_f32 v84, v116, v117
    v_cvt_pk_bf16_f32 v85, v118, v119
    v_cvt_pk_bf16_f32 v86, v120, v121
    v_cvt_pk_bf16_f32 v87, v122, v123
    v_cvt_pk_bf16_f32 v88, v124, v125
    v_cvt_pk_bf16_f32 v89, v126, v127
    v_cvt_pk_bf16_f32 v90, v128, v129
    v_cvt_pk_bf16_f32 v91, v130, v131
    buffer_store_dwordx4 v[84:87], v219, s[52:55], s7 offen sc1
    buffer_store_dwordx4 v[88:91], v219, s[52:55], s7 offen offset:64 sc1
B_FINAL:
    s_mov_b32 s64, s36
    s_and_b32 s65, s37, 0xffff
    s_mov_b32 s66, 1835008
    s_mov_b32 s67, 0x20000
    s_lshl_b32 s7, s6, 6
    s_lshl_b32 s8, s69, 5
    s_add_u32 s7, s7, s8
    v_and_b32 v12, 31, v2
    v_add_u32 v13, s7, v12
    v_lshlrev_b32 v14, 3, v13
    v_add_u32 v14, 12582912, v14
    v_mul_u32_u24 v7, 896, v13
    v_lshrrev_b32 v15, 5, v2
    v_lshl_add_u32 v7, v15, 3, v7
    s_lshl_b32 s11, s9, 6
    s_lshl_b32 s8, s68, 5
    s_add_u32 s11, s11, s8
    s_lshl_b32 s8, s11, 1
    v_add_u32 v7, s8, v7
    s_lshl_b32 s12, s7, 1
    s_add_u32 s12, s12, 10485760
    s_add_u32 s28, s12, 65536
    s_lshr_b32 s7, s6, 4
    s_mul_i32 s7, s7, 448
    s_add_u32 s7, s7, s11
    s_lshl_b32 s7, s7, 7
    s_add_u32 s7, s7, 13107200
    v_lshl_add_u32 v8, v12, 7, s7
    v_lshrrev_b32 v12, 2, v2
    v_add_u32 v12, s11, v12
    v_lshlrev_b32 v12, 12, v12
    v_and_b32 v13, 3, v2
    v_lshl_add_u32 v9, v13, 4, v12
    s_lshl_b32 s8, s68, 11
    s_add_u32 s8, s8, s22
    s_add_u32 s8, s8, 8192
    v_add_u32 v10, s8, v1
    v_bfe_u32 v12, v2, 2, 2
    v_lshl_add_u32 v12, v15, 2, v12
    v_lshlrev_b32 v12, 6, v12
    v_bfe_u32 v16, v2, 4, 1
    v_lshl_add_u32 v12, v16, 5, v12
    v_lshl_add_u32 v12, v13, 3, v12
    v_add_u32 v11, s8, v12
    s_lshl_b32 s8, s10, 14
    s_add_u32 s8, s8, 49152
    v_add_u32 v25, s8, v1
    v_lshlrev_b32 v16, 2, v13
    v_add_u32 v16, 45632, v16
    s_waitcnt vmcnt(0)
    s_mov_b64 exec, 1
    buffer_store_dword v23, v20, s[52:55], s15 offen sc1
    s_mov_b64 exec, -1
    buffer_load_dwordx2 v[28:29], v7, s[44:47], 0 offen offset:0
    buffer_load_dwordx2 v[30:31], v7, s[44:47], 0 offen offset:16
    buffer_load_dwordx2 v[32:33], v7, s[44:47], 0 offen offset:32
    buffer_load_dwordx2 v[34:35], v7, s[44:47], 0 offen offset:48
    buffer_load_dwordx2 v[26:27], v14, s[52:55], 0 offen sc1
    s_mov_b32 s42, 0
TG_22:
    s_sleep 1
    ds_read_b32 v15, v16 offset:16
    s_add_u32 s42, s42, 1
    s_cmp_gt_u32 s42, 0x100000
    s_cbranch_scc1 TGOK_23
    s_waitcnt lgkmcnt(0)
    v_cmp_eq_u32 vcc, v23, v15
    s_nop 3
    s_cmp_eq_u64 vcc, exec
    s_cbranch_scc0 TG_22
TGOK_23:
    s_waitcnt lgkmcnt(0)
    s_mov_b32 s42, 0
    buffer_load_dword v21, v8, s[52:55], 0 offen sc1
    s_waitcnt vmcnt(0)
BT_24:
    v_cmp_eq_u32 vcc, v23, v21
    s_add_u32 s42, s42, 1
    s_cmp_gt_u32 s42, 0x10000
    s_cbranch_scc1 BTOK_25
    s_cmp_eq_u64 vcc, exec
    s_cbranch_scc1 BTOK_25
    s_sleep 8
    buffer_load_dword v21, v8, s[52:55], 0 offen sc1
    s_waitcnt vmcnt(0)
    s_branch BT_24
BTOK_25:
    buffer_load_dwordx4 v[36:39], v9, s[52:55], s12 offen sc1
    buffer_load_dwordx4 v[40:43], v9, s[52:55], s28 offen sc1
    v_lshlrev_b32 v52, 16, v28
    v_and_b32 v53, 0xffff0000, v28
    v_lshlrev_b32 v54, 16, v29
    v_and_b32 v55, 0xffff0000, v29
    v_lshlrev_b32 v56, 16, v30
    v_and_b32 v57, 0xffff0000, v30
    v_lshlrev_b32 v58, 16, v31
    v_and_b32 v59, 0xffff0000, v31
    v_lshlrev_b32 v60, 16, v32
    v_and_b32 v61, 0xffff0000, v32
    v_lshlrev_b32 v62, 16, v33
    v_and_b32 v63, 0xffff0000, v33
    v_lshlrev_b32 v64, 16, v34
    v_and_b32 v65, 0xffff0000, v34
    v_lshlrev_b32 v66, 16, v35
    v_and_b32 v67, 0xffff0000, v35
    v_sub_f32 v68, v52, v26
    v_sub_f32 v69, v53, v26
    v_sub_f32 v70, v54, v26
    v_sub_f32 v71, v55, v26
    v_sub_f32 v72, v56, v26
    v_sub_f32 v73, v57, v26
    v_sub_f32 v74, v58, v26
    v_sub_f32 v75, v59, v26
    v_sub_f32 v76, v60, v26
    v_sub_f32 v77, v61, v26
    v_sub_f32 v78, v62, v26
    v_sub_f32 v79, v63, v26
    v_sub_f32 v80, v64, v26
    v_sub_f32 v81, v65, v26
    v_sub_f32 v82, v66, v26
    v_sub_f32 v83, v67, v26
    v_cvt_pk_bf16_f32 v69, v68, v69
    v_lshlrev_b32 v68, 16, v69
    v_and_b32 v69, 0xffff0000, v69
    v_cvt_pk_bf16_f32 v71, v70, v71
    v_lshlrev_b32 v70, 16, v71
    v_and_b32 v71, 0xffff0000, v71
    v_cvt_pk_bf16_f32 v73, v72, v73
    v_lshlrev_b32 v72, 16, v73
    v_and_b32 v73, 0xffff0000, v73
    v_cvt_pk_bf16_f32 v75, v74, v75
    v_lshlrev_b32 v74, 16, v75
    v_and_b32 v75, 0xffff0000, v75
    v_cvt_pk_bf16_f32 v77, v76, v77
    v_lshlrev_b32 v76, 16, v77
    v_and_b32 v77, 0xffff0000, v77
    v_cvt_pk_bf16_f32 v79, v78, v79
    v_lshlrev_b32 v78, 16, v79
    v_and_b32 v79, 0xffff0000, v79
    v_cvt_pk_bf16_f32 v81, v80, v81
    v_lshlrev_b32 v80, 16, v81
    v_and_b32 v81, 0xffff0000, v81
    v_cvt_pk_bf16_f32 v83, v82, v83
    v_lshlrev_b32 v82, 16, v83
    v_and_b32 v83, 0xffff0000, v83
    v_mul_f32 v68, v68, v27
    v_mul_f32 v69, v69, v27
    v_mul_f32 v70, v70, v27
    v_mul_f32 v71, v71, v27
    v_mul_f32 v72, v72, v27
    v_mul_f32 v73, v73, v27
    v_mul_f32 v74, v74, v27
    v_mul_f32 v75, v75, v27
    v_mul_f32 v76, v76, v27
    v_mul_f32 v77, v77, v27
    v_mul_f32 v78, v78, v27
    v_mul_f32 v79, v79, v27
    v_mul_f32 v80, v80, v27
    v_mul_f32 v81, v81, v27
    v_mul_f32 v82, v82, v27
    v_mul_f32 v83, v83, v27
    v_cvt_pk_bf16_f32 v69, v68, v69
    v_lshlrev_b32 v68, 16, v69
    v_and_b32 v69, 0xffff0000, v69
    v_cvt_pk_bf16_f32 v71, v70, v71
    v_lshlrev_b32 v70, 16, v71
    v_and_b32 v71, 0xffff0000, v71
    v_cvt_pk_bf16_f32 v73, v72, v73
    v_lshlrev_b32 v72, 16, v73
    v_and_b32 v73, 0xffff0000, v73
    v_cvt_pk_bf16_f32 v75, v74, v75
    v_lshlrev_b32 v74, 16, v75
    v_and_b32 v75, 0xffff0000, v75
    v_cvt_pk_bf16_f32 v77, v76, v77
    v_lshlrev_b32 v76, 16, v77
    v_and_b32 v77, 0xffff0000, v77
    v_cvt_pk_bf16_f32 v79, v78, v79
    v_lshlrev_b32 v78, 16, v79
    v_and_b32 v79, 0xffff0000, v79
    v_cvt_pk_bf16_f32 v81, v80, v81
    v_lshlrev_b32 v80, 16, v81
    v_and_b32 v81, 0xffff0000, v81
    v_cvt_pk_bf16_f32 v83, v82, v83
    v_lshlrev_b32 v82, 16, v83
    v_and_b32 v83, 0xffff0000, v83
    s_waitcnt vmcnt(0)
    ds_write_b128 v10, v[36:39]
    ds_write_b128 v10, v[40:43] offset:1024
    s_waitcnt lgkmcnt(0)
    ds_read_b64_tr_b16 v[44:45], v11 offset:0
    ds_read_b64_tr_b16 v[46:47], v11 offset:512
    ds_read_b64_tr_b16 v[48:49], v11 offset:1024
    ds_read_b64_tr_b16 v[50:51], v11 offset:1536
    s_waitcnt lgkmcnt(0)
    v_lshlrev_b32 v164, 16, v44
    v_and_b32 v165, 0xffff0000, v44
    v_lshlrev_b32 v166, 16, v45
    v_and_b32 v167, 0xffff0000, v45
    v_lshlrev_b32 v168, 16, v46
    v_and_b32 v169, 0xffff0000, v46
    v_lshlrev_b32 v170, 16, v47
    v_and_b32 v171, 0xffff0000, v47
    v_lshlrev_b32 v172, 16, v48
    v_and_b32 v173, 0xffff0000, v48
    v_lshlrev_b32 v174, 16, v49
    v_and_b32 v175, 0xffff0000, v49
    v_lshlrev_b32 v176, 16, v50
    v_and_b32 v177, 0xffff0000, v50
    v_lshlrev_b32 v178, 16, v51
    v_and_b32 v179, 0xffff0000, v51
    v_pk_mul_f32 v[164:165], v[164:165], v[68:69]
    v_pk_mul_f32 v[166:167], v[166:167], v[70:71]
    v_pk_mul_f32 v[168:169], v[168:169], v[72:73]
    v_pk_mul_f32 v[170:171], v[170:171], v[74:75]
    v_pk_mul_f32 v[172:173], v[172:173], v[76:77]
    v_pk_mul_f32 v[174:175], v[174:175], v[78:79]
    v_pk_mul_f32 v[176:177], v[176:177], v[80:81]
    v_pk_mul_f32 v[178:179], v[178:179], v[82:83]
    v_cvt_pk_bf16_f32 v165, v164, v165
    v_lshlrev_b32 v164, 16, v165
    v_and_b32 v165, 0xffff0000, v165
    v_cvt_pk_bf16_f32 v167, v166, v167
    v_lshlrev_b32 v166, 16, v167
    v_and_b32 v167, 0xffff0000, v167
    v_cvt_pk_bf16_f32 v169, v168, v169
    v_lshlrev_b32 v168, 16, v169
    v_and_b32 v169, 0xffff0000, v169
    v_cvt_pk_bf16_f32 v171, v170, v171
    v_lshlrev_b32 v170, 16, v171
    v_and_b32 v171, 0xffff0000, v171
    v_cvt_pk_bf16_f32 v173, v172, v173
    v_lshlrev_b32 v172, 16, v173
    v_and_b32 v173, 0xffff0000, v173
    v_cvt_pk_bf16_f32 v175, v174, v175
    v_lshlrev_b32 v174, 16, v175
    v_and_b32 v175, 0xffff0000, v175
    v_cvt_pk_bf16_f32 v177, v176, v177
    v_lshlrev_b32 v176, 16, v177
    v_and_b32 v177, 0xffff0000, v177
    v_cvt_pk_bf16_f32 v179, v178, v179
    v_lshlrev_b32 v178, 16, v179
    v_and_b32 v179, 0xffff0000, v179
    s_mov_b32 s28, 0xbfb8aa3b
    s_mov_b32 s42, 0
GR_26:
    s_sleep 1
    ds_read_b32 v15, v16 offset:0
    s_add_u32 s42, s42, 1
    s_cmp_gt_u32 s42, 0x100000
    s_cbranch_scc1 GROK_27
    s_waitcnt lgkmcnt(0)
    v_cmp_eq_u32 vcc, v23, v15
    s_nop 3
    s_cmp_eq_u64 vcc, exec
    s_cbranch_scc0 GR_26
GROK_27:
    s_waitcnt lgkmcnt(0)
    ds_read_b128 v[84:87], v25 offset:0
    ds_read_b128 v[88:91], v25 offset:1024
    ds_read_b128 v[92:95], v25 offset:2048
    ds_read_b128 v[96:99], v25 offset:3072
    ds_read_b128 v[100:103], v25 offset:4096
    ds_read_b128 v[104:107], v25 offset:5120
    ds_read_b128 v[108:111], v25 offset:6144
    ds_read_b128 v[112:115], v25 offset:7168
    ds_read_b128 v[116:119], v25 offset:8192
    ds_read_b128 v[120:123], v25 offset:9216
    ds_read_b128 v[124:127], v25 offset:10240
    ds_read_b128 v[128:131], v25 offset:11264
    ds_read_b128 v[132:135], v25 offset:12288
    ds_read_b128 v[136:139], v25 offset:13312
    ds_read_b128 v[140:143], v25 offset:14336
    ds_read_b128 v[144:147], v25 offset:15360
    s_waitcnt lgkmcnt(8)
    v_pk_add_f32 v[84:85], v[84:85], v[100:101]
    v_pk_add_f32 v[86:87], v[86:87], v[102:103]
    v_pk_add_f32 v[88:89], v[88:89], v[104:105]
    v_pk_add_f32 v[90:91], v[90:91], v[106:107]
    v_pk_add_f32 v[92:93], v[92:93], v[108:109]
    v_pk_add_f32 v[94:95], v[94:95], v[110:111]
    v_pk_add_f32 v[96:97], v[96:97], v[112:113]
    v_pk_add_f32 v[98:99], v[98:99], v[114:115]
    s_waitcnt lgkmcnt(0)
    v_pk_add_f32 v[116:117], v[116:117], v[132:133]
    v_pk_add_f32 v[118:119], v[118:119], v[134:135]
    v_pk_add_f32 v[120:121], v[120:121], v[136:137]
    v_pk_add_f32 v[122:123], v[122:123], v[138:139]
    v_pk_add_f32 v[124:125], v[124:125], v[140:141]
    v_pk_add_f32 v[126:127], v[126:127], v[142:143]
    v_pk_add_f32 v[128:129], v[128:129], v[144:145]
    v_pk_add_f32 v[130:131], v[130:131], v[146:147]
    v_pk_add_f32 v[84:85], v[84:85], v[116:117]
    v_pk_add_f32 v[86:87], v[86:87], v[118:119]
    v_pk_add_f32 v[88:89], v[88:89], v[120:121]
    v_pk_add_f32 v[90:91], v[90:91], v[122:123]
    v_pk_add_f32 v[92:93], v[92:93], v[124:125]
    v_pk_add_f32 v[94:95], v[94:95], v[126:127]
    v_pk_add_f32 v[96:97], v[96:97], v[128:129]
    v_pk_add_f32 v[98:99], v[98:99], v[130:131]
    v_cvt_pk_bf16_f32 v85, v84, v85
    v_lshlrev_b32 v84, 16, v85
    v_and_b32 v85, 0xffff0000, v85
    v_cvt_pk_bf16_f32 v87, v86, v87
    v_lshlrev_b32 v86, 16, v87
    v_and_b32 v87, 0xffff0000, v87
    v_cvt_pk_bf16_f32 v89, v88, v89
    v_lshlrev_b32 v88, 16, v89
    v_and_b32 v89, 0xffff0000, v89
    v_cvt_pk_bf16_f32 v91, v90, v91
    v_lshlrev_b32 v90, 16, v91
    v_and_b32 v91, 0xffff0000, v91
    v_cvt_pk_bf16_f32 v93, v92, v93
    v_lshlrev_b32 v92, 16, v93
    v_and_b32 v93, 0xffff0000, v93
    v_cvt_pk_bf16_f32 v95, v94, v95
    v_lshlrev_b32 v94, 16, v95
    v_and_b32 v95, 0xffff0000, v95
    v_cvt_pk_bf16_f32 v97, v96, v97
    v_lshlrev_b32 v96, 16, v97
    v_and_b32 v97, 0xffff0000, v97
    v_cvt_pk_bf16_f32 v99, v98, v99
    v_lshlrev_b32 v98, 16, v99
    v_and_b32 v99, 0xffff0000, v99
    v_mul_f32 v148, s28, v84
    v_mul_f32 v149, s28, v85
    v_mul_f32 v150, s28, v86
    v_mul_f32 v151, s28, v87
    v_mul_f32 v152, s28, v88
    v_mul_f32 v153, s28, v89
    v_mul_f32 v154, s28, v90
    v_mul_f32 v155, s28, v91
    v_mul_f32 v156, s28, v92
    v_mul_f32 v157, s28, v93
    v_mul_f32 v158, s28, v94
    v_mul_f32 v159, s28, v95
    v_mul_f32 v160, s28, v96
    v_mul_f32 v161, s28, v97
    v_mul_f32 v162, s28, v98
    v_mul_f32 v163, s28, v99
    v_exp_f32 v148, v148
    v_exp_f32 v149, v149
    v_exp_f32 v150, v150
    v_exp_f32 v151, v151
    v_exp_f32 v152, v152
    v_exp_f32 v153, v153
    v_exp_f32 v154, v154
    v_exp_f32 v155, v155
    v_exp_f32 v156, v156
    v_exp_f32 v157, v157
    v_exp_f32 v158, v158
    v_exp_f32 v159, v159
    v_exp_f32 v160, v160
    v_exp_f32 v161, v161
    v_exp_f32 v162, v162
    v_exp_f32 v163, v163
    v_add_f32 v148, 1.0, v148
    v_add_f32 v149, 1.0, v149
    v_add_f32 v150, 1.0, v150
    v_add_f32 v151, 1.0, v151
    v_add_f32 v152, 1.0, v152
    v_add_f32 v153, 1.0, v153
    v_add_f32 v154, 1.0, v154
    v_add_f32 v155, 1.0, v155
    v_add_f32 v156, 1.0, v156
    v_add_f32 v157, 1.0, v157
    v_add_f32 v158, 1.0, v158
    v_add_f32 v159, 1.0, v159
    v_add_f32 v160, 1.0, v160
    v_add_f32 v161, 1.0, v161
    v_add_f32 v162, 1.0, v162
    v_add_f32 v163, 1.0, v163
    v_rcp_f32 v148, v148
    v_rcp_f32 v149, v149
    v_rcp_f32 v150, v150
    v_rcp_f32 v151, v151
    v_rcp_f32 v152, v152
    v_rcp_f32 v153, v153
    v_rcp_f32 v154, v154
    v_rcp_f32 v155, v155
    v_rcp_f32 v156, v156
    v_rcp_f32 v157, v157
    v_rcp_f32 v158, v158
    v_rcp_f32 v159, v159
    v_rcp_f32 v160, v160
    v_rcp_f32 v161, v161
    v_rcp_f32 v162, v162
    v_rcp_f32 v163, v163
    s_nop 0
    v_pk_mul_f32 v[84:85], v[84:85], v[148:149]
    v_pk_mul_f32 v[86:87], v[86:87], v[150:151]
    v_pk_mul_f32 v[88:89], v[88:89], v[152:153]
    v_pk_mul_f32 v[90:91], v[90:91], v[154:155]
    v_pk_mul_f32 v[92:93], v[92:93], v[156:157]
    v_pk_mul_f32 v[94:95], v[94:95], v[158:159]
    v_pk_mul_f32 v[96:97], v[96:97], v[160:161]
    v_pk_mul_f32 v[98:99], v[98:99], v[162:163]
    v_cvt_pk_bf16_f32 v85, v84, v85
    v_lshlrev_b32 v84, 16, v85
    v_and_b32 v85, 0xffff0000, v85
    v_cvt_pk_bf16_f32 v87, v86, v87
    v_lshlrev_b32 v86, 16, v87
    v_and_b32 v87, 0xffff0000, v87
    v_cvt_pk_bf16_f32 v89, v88, v89
    v_lshlrev_b32 v88, 16, v89
    v_and_b32 v89, 0xffff0000, v89
    v_cvt_pk_bf16_f32 v91, v90, v91
    v_lshlrev_b32 v90, 16, v91
    v_and_b32 v91, 0xffff0000, v91
    v_cvt_pk_bf16_f32 v93, v92, v93
    v_lshlrev_b32 v92, 16, v93
    v_and_b32 v93, 0xffff0000, v93
    v_cvt_pk_bf16_f32 v95, v94, v95
    v_lshlrev_b32 v94, 16, v95
    v_and_b32 v95, 0xffff0000, v95
    v_cvt_pk_bf16_f32 v97, v96, v97
    v_lshlrev_b32 v96, 16, v97
    v_and_b32 v97, 0xffff0000, v97
    v_cvt_pk_bf16_f32 v99, v98, v99
    v_lshlrev_b32 v98, 16, v99
    v_and_b32 v99, 0xffff0000, v99
    v_pk_mul_f32 v[164:165], v[164:165], v[84:85]
    v_pk_mul_f32 v[166:167], v[166:167], v[86:87]
    v_pk_mul_f32 v[168:169], v[168:169], v[88:89]
    v_pk_mul_f32 v[170:171], v[170:171], v[90:91]
    v_pk_mul_f32 v[172:173], v[172:173], v[92:93]
    v_pk_mul_f32 v[174:175], v[174:175], v[94:95]
    v_pk_mul_f32 v[176:177], v[176:177], v[96:97]
    v_pk_mul_f32 v[178:179], v[178:179], v[98:99]
    v_cvt_pk_bf16_f32 v165, v164, v165
    v_lshlrev_b32 v164, 16, v165
    v_and_b32 v165, 0xffff0000, v165
    v_cvt_pk_bf16_f32 v167, v166, v167
    v_lshlrev_b32 v166, 16, v167
    v_and_b32 v167, 0xffff0000, v167
    v_cvt_pk_bf16_f32 v169, v168, v169
    v_lshlrev_b32 v168, 16, v169
    v_and_b32 v169, 0xffff0000, v169
    v_cvt_pk_bf16_f32 v171, v170, v171
    v_lshlrev_b32 v170, 16, v171
    v_and_b32 v171, 0xffff0000, v171
    v_cvt_pk_bf16_f32 v173, v172, v173
    v_lshlrev_b32 v172, 16, v173
    v_and_b32 v173, 0xffff0000, v173
    v_cvt_pk_bf16_f32 v175, v174, v175
    v_lshlrev_b32 v174, 16, v175
    v_and_b32 v175, 0xffff0000, v175
    v_cvt_pk_bf16_f32 v177, v176, v177
    v_lshlrev_b32 v176, 16, v177
    v_and_b32 v177, 0xffff0000, v177
    v_cvt_pk_bf16_f32 v179, v178, v179
    v_lshlrev_b32 v178, 16, v179
    v_and_b32 v179, 0xffff0000, v179
    v_pk_add_f32 v[164:165], v[164:165], v[52:53]
    v_pk_add_f32 v[166:167], v[166:167], v[54:55]
    v_pk_add_f32 v[168:169], v[168:169], v[56:57]
    v_pk_add_f32 v[170:171], v[170:171], v[58:59]
    v_pk_add_f32 v[172:173], v[172:173], v[60:61]
    v_pk_add_f32 v[174:175], v[174:175], v[62:63]
    v_pk_add_f32 v[176:177], v[176:177], v[64:65]
    v_pk_add_f32 v[178:179], v[178:179], v[66:67]
    v_cvt_pk_bf16_f32 v36, v164, v165
    v_cvt_pk_bf16_f32 v37, v166, v167
    v_cvt_pk_bf16_f32 v38, v168, v169
    v_cvt_pk_bf16_f32 v39, v170, v171
    v_cvt_pk_bf16_f32 v40, v172, v173
    v_cvt_pk_bf16_f32 v41, v174, v175
    v_cvt_pk_bf16_f32 v42, v176, v177
    v_cvt_pk_bf16_f32 v43, v178, v179
    buffer_store_dwordx2 v[36:37], v7, s[64:67], 0 offen offset:0
    buffer_store_dwordx2 v[38:39], v7, s[64:67], 0 offen offset:16
    buffer_store_dwordx2 v[40:41], v7, s[64:67], 0 offen offset:32
    buffer_store_dwordx2 v[42:43], v7, s[64:67], 0 offen offset:48
    s_endpgm
K_PREP:
    s_sub_u32 s4, s2, 224
    s_and_b32 s7, s4, 3
    s_lshr_b32 s8, s4, 3
    s_bfe_u32 s9, s4, 0x10002
    s_lshl_b32 s12, s7, 3
    s_lshl_b32 s13, s9, 2
    s_add_u32 s12, s12, s13
    s_add_u32 s12, s12, s8
    s_lshl_b32 s13, s7, 2
    s_add_u32 s13, s13, s8
    s_mul_i32 s9, s9, 7
    s_cmp_ge_u32 s13, 7
    s_cselect_b32 s7, 7, 0
    s_add_u32 s9, s9, s7
    s_add_u32 s9, s9, s13
    s_cmp_ge_u32 s13, 14
    s_cselect_b32 s13, 28, s9
    s_lshl_b32 s5, s12, 6
    v_lshrrev_b32 v9, 3, v0
    v_add_u32 v10, s5, v9
    v_mul_u32_u24 v10, 896, v10
    v_and_b32 v11, 7, v0
    v_lshl_add_u32 v10, v11, 4, v10
    s_cmp_ge_u32 s13, 14
    s_cselect_b32 s6, 14, 0
    s_sub_u32 s6, s13, s6
    v_lshrrev_b32 v12, 4, v0
    v_mul_u32_u24 v12, 3584, v12
    v_and_b32 v13, 15, v0
    v_lshl_add_u32 v12, v13, 4, v12
    s_lshl_b32 s9, s6, 8
    v_mov_b32 v20, 0
    s_waitcnt lgkmcnt(0)
    s_cmp_ge_u32 s13, 14
    s_cselect_b32 s48, s32, s30
    s_cselect_b32 s49, s33, s31
    s_and_b32 s49, s49, 0xffff
    s_mov_b32 s50, 1605632
    s_mov_b32 s51, 0x20000
    s_cmp_ge_u32 s13, 28
    s_cselect_b32 s50, 0, s50
    s_mov_b32 s44, s16
    s_and_b32 s45, s17, 0xffff
    s_mov_b32 s46, 1835008
    s_mov_b32 s47, 0x20000
    s_mov_b32 s56, s38
    s_and_b32 s57, s39, 0xffff
    s_mov_b32 s58, 256
    s_mov_b32 s59, 0x20000
    s_add_u32 s7, s4, s3
    s_cmp_lg_u32 s7, 0
    s_cbranch_scc1 P_NOTAG
    s_memrealtime s[42:43]
    s_waitcnt lgkmcnt(0)
    s_lshl_b32 s43, s43, 29
    s_xor_b32 s42, s42, s43
    s_or_b32 s42, s42, 1
    v_mov_b32 v23, s42
    s_mov_b64 exec, 1
    buffer_store_dword v23, v20, s[56:59], 0 offen sc1
    s_mov_b64 exec, -1
P_NOTAG:
    buffer_load_dwordx4 v[52:55], v12, s[48:51], s9 offen
    s_add_u32 s9, s9, 114688
    buffer_load_dwordx4 v[56:59], v12, s[48:51], s9 offen
    s_add_u32 s9, s9, 114688
    buffer_load_dwordx4 v[60:63], v12, s[48:51], s9 offen
    s_add_u32 s9, s9, 114688
    buffer_load_dwordx4 v[64:67], v12, s[48:51], s9 offen
    s_add_u32 s9, s9, 114688
    buffer_load_dwordx4 v[68:71], v12, s[48:51], s9 offen
    s_add_u32 s9, s9, 114688
    buffer_load_dwordx4 v[72:75], v12, s[48:51], s9 offen
    s_add_u32 s9, s9, 114688
    buffer_load_dwordx4 v[76:79], v12, s[48:51], s9 offen
    s_add_u32 s9, s9, 114688
    buffer_load_dwordx4 v[80:83], v12, s[48:51], s9 offen
    s_add_u32 s9, s9, 114688
    buffer_load_dwordx4 v[84:87], v12, s[48:51], s9 offen
    s_add_u32 s9, s9, 114688
    buffer_load_dwordx4 v[88:91], v12, s[48:51], s9 offen
    s_add_u32 s9, s9, 114688
    buffer_load_dwordx4 v[92:95], v12, s[48:51], s9 offen
    s_add_u32 s9, s9, 114688
    buffer_load_dwordx4 v[96:99], v12, s[48:51], s9 offen
    s_add_u32 s9, s9, 114688
    buffer_load_dwordx4 v[100:103], v12, s[48:51], s9 offen
    s_add_u32 s9, s9, 114688
    buffer_load_dwordx4 v[104:107], v12, s[48:51], s9 offen
    buffer_load_dwordx4 v[24:27], v10, s[44:47], 0 offen offset:0
    buffer_load_dwordx4 v[28:31], v10, s[44:47], 0 offen offset:128
    buffer_load_dwordx4 v[32:35], v10, s[44:47], 0 offen offset:256
    buffer_load_dwordx4 v[36:39], v10, s[44:47], 0 offen offset:384
    buffer_load_dwordx4 v[40:43], v10, s[44:47], 0 offen offset:512
    buffer_load_dwordx4 v[44:47], v10, s[44:47], 0 offen offset:640
    buffer_load_dwordx4 v[48:51], v10, s[44:47], 0 offen offset:768
    v_mul_u32_u24 v3, 1171, v0
    v_lshrrev_b32 v3, 16, v3
    v_mul_u32_u24 v4, 56, v3
    v_sub_u32 v4, v0, v4
    v_lshl_add_u32 v5, v3, 3, s5
    v_mul_u32_u24 v5, 896, v5
    v_lshl_add_u32 v5, v4, 4, v5
    v_add_u32 v6, 3584, v5
    v_subrev_u32 v7, 2688, v5
    v_lshlrev_b32 v8, 6, v4
    s_mov_b32 s76, s18
    s_and_b32 s77, s19, 0xffff
    s_mov_b32 s78, 1835008
    s_mov_b32 s79, 0x20000
    s_mov_b32 s80, s20
    s_and_b32 s81, s21, 0xffff
    s_mov_b32 s82, 1835008
    s_mov_b32 s83, 0x20000
    s_mov_b32 s84, s22
    s_and_b32 s85, s23, 0xffff
    s_mov_b32 s86, 3584
    s_mov_b32 s87, 0x20000
    s_mov_b32 s52, s40
    s_and_b32 s53, s41, 0xffff
    s_mov_b32 s54, 13631488
    s_mov_b32 s55, 0x20000
    v_mov_b32 v120, 0
    v_mov_b32 v121, 0
    v_mov_b32 v122, 0
    v_mov_b32 v123, 0
    v_mov_b32 v124, 0
    v_mov_b32 v125, 0
    v_mov_b32 v126, 0
    v_mov_b32 v127, 0
    s_waitcnt vmcnt(20)
    v_lshlrev_b32 v108, 16, v52
    v_and_b32 v109, 0xffff0000, v52
    v_lshlrev_b32 v110, 16, v53
    v_and_b32 v111, 0xffff0000, v53
    v_lshlrev_b32 v112, 16, v54
    v_and_b32 v113, 0xffff0000, v54
    v_lshlrev_b32 v114, 16, v55
    v_and_b32 v115, 0xffff0000, v55
    v_pk_add_f32 v[120:121], v[120:121], v[108:109]
    v_pk_add_f32 v[122:123], v[122:123], v[110:111]
    v_pk_add_f32 v[124:125], v[124:125], v[112:113]
    v_pk_add_f32 v[126:127], v[126:127], v[114:115]
    s_waitcnt vmcnt(19)
    v_lshlrev_b32 v108, 16, v56
    v_and_b32 v109, 0xffff0000, v56
    v_lshlrev_b32 v110, 16, v57
    v_and_b32 v111, 0xffff0000, v57
    v_lshlrev_b32 v112, 16, v58
    v_and_b32 v113, 0xffff0000, v58
    v_lshlrev_b32 v114, 16, v59
    v_and_b32 v115, 0xffff0000, v59
    v_pk_add_f32 v[120:121], v[120:121], v[108:109]
    v_pk_add_f32 v[122:123], v[122:123], v[110:111]
    v_pk_add_f32 v[124:125], v[124:125], v[112:113]
    v_pk_add_f32 v[126:127], v[126:127], v[114:115]
    s_waitcnt vmcnt(18)
    v_lshlrev_b32 v108, 16, v60
    v_and_b32 v109, 0xffff0000, v60
    v_lshlrev_b32 v110, 16, v61
    v_and_b32 v111, 0xffff0000, v61
    v_lshlrev_b32 v112, 16, v62
    v_and_b32 v113, 0xffff0000, v62
    v_lshlrev_b32 v114, 16, v63
    v_and_b32 v115, 0xffff0000, v63
    v_pk_add_f32 v[120:121], v[120:121], v[108:109]
    v_pk_add_f32 v[122:123], v[122:123], v[110:111]
    v_pk_add_f32 v[124:125], v[124:125], v[112:113]
    v_pk_add_f32 v[126:127], v[126:127], v[114:115]
    s_waitcnt vmcnt(17)
    v_lshlrev_b32 v108, 16, v64
    v_and_b32 v109, 0xffff0000, v64
    v_lshlrev_b32 v110, 16, v65
    v_and_b32 v111, 0xffff0000, v65
    v_lshlrev_b32 v112, 16, v66
    v_and_b32 v113, 0xffff0000, v66
    v_lshlrev_b32 v114, 16, v67
    v_and_b32 v115, 0xffff0000, v67
    v_pk_add_f32 v[120:121], v[120:121], v[108:109]
    v_pk_add_f32 v[122:123], v[122:123], v[110:111]
    v_pk_add_f32 v[124:125], v[124:125], v[112:113]
    v_pk_add_f32 v[126:127], v[126:127], v[114:115]
    s_waitcnt vmcnt(16)
    v_lshlrev_b32 v108, 16, v68
    v_and_b32 v109, 0xffff0000, v68
    v_lshlrev_b32 v110, 16, v69
    v_and_b32 v111, 0xffff0000, v69
    v_lshlrev_b32 v112, 16, v70
    v_and_b32 v113, 0xffff0000, v70
    v_lshlrev_b32 v114, 16, v71
    v_and_b32 v115, 0xffff0000, v71
    v_pk_add_f32 v[120:121], v[120:121], v[108:109]
    v_pk_add_f32 v[122:123], v[122:123], v[110:111]
    v_pk_add_f32 v[124:125], v[124:125], v[112:113]
    v_pk_add_f32 v[126:127], v[126:127], v[114:115]
    s_waitcnt vmcnt(15)
    v_lshlrev_b32 v108, 16, v72
    v_and_b32 v109, 0xffff0000, v72
    v_lshlrev_b32 v110, 16, v73
    v_and_b32 v111, 0xffff0000, v73
    v_lshlrev_b32 v112, 16, v74
    v_and_b32 v113, 0xffff0000, v74
    v_lshlrev_b32 v114, 16, v75
    v_and_b32 v115, 0xffff0000, v75
    v_pk_add_f32 v[120:121], v[120:121], v[108:109]
    v_pk_add_f32 v[122:123], v[122:123], v[110:111]
    v_pk_add_f32 v[124:125], v[124:125], v[112:113]
    v_pk_add_f32 v[126:127], v[126:127], v[114:115]
    s_waitcnt vmcnt(14)
    v_lshlrev_b32 v108, 16, v76
    v_and_b32 v109, 0xffff0000, v76
    v_lshlrev_b32 v110, 16, v77
    v_and_b32 v111, 0xffff0000, v77
    v_lshlrev_b32 v112, 16, v78
    v_and_b32 v113, 0xffff0000, v78
    v_lshlrev_b32 v114, 16, v79
    v_and_b32 v115, 0xffff0000, v79
    v_pk_add_f32 v[120:121], v[120:121], v[108:109]
    v_pk_add_f32 v[122:123], v[122:123], v[110:111]
    v_pk_add_f32 v[124:125], v[124:125], v[112:113]
    v_pk_add_f32 v[126:127], v[126:127], v[114:115]
    s_waitcnt vmcnt(13)
    v_lshlrev_b32 v108, 16, v80
    v_and_b32 v109, 0xffff0000, v80
    v_lshlrev_b32 v110, 16, v81
    v_and_b32 v111, 0xffff0000, v81
    v_lshlrev_b32 v112, 16, v82
    v_and_b32 v113, 0xffff0000, v82
    v_lshlrev_b32 v114, 16, v83
    v_and_b32 v115, 0xffff0000, v83
    v_pk_add_f32 v[120:121], v[120:121], v[108:109]
    v_pk_add_f32 v[122:123], v[122:123], v[110:111]
    v_pk_add_f32 v[124:125], v[124:125], v[112:113]
    v_pk_add_f32 v[126:127], v[126:127], v[114:115]
    s_waitcnt vmcnt(12)
    v_lshlrev_b32 v108, 16, v84
    v_and_b32 v109, 0xffff0000, v84
    v_lshlrev_b32 v110, 16, v85
    v_and_b32 v111, 0xffff0000, v85
    v_lshlrev_b32 v112, 16, v86
    v_and_b32 v113, 0xffff0000, v86
    v_lshlrev_b32 v114, 16, v87
    v_and_b32 v115, 0xffff0000, v87
    v_pk_add_f32 v[120:121], v[120:121], v[108:109]
    v_pk_add_f32 v[122:123], v[122:123], v[110:111]
    v_pk_add_f32 v[124:125], v[124:125], v[112:113]
    v_pk_add_f32 v[126:127], v[126:127], v[114:115]
    s_waitcnt vmcnt(11)
    v_lshlrev_b32 v108, 16, v88
    v_and_b32 v109, 0xffff0000, v88
    v_lshlrev_b32 v110, 16, v89
    v_and_b32 v111, 0xffff0000, v89
    v_lshlrev_b32 v112, 16, v90
    v_and_b32 v113, 0xffff0000, v90
    v_lshlrev_b32 v114, 16, v91
    v_and_b32 v115, 0xffff0000, v91
    v_pk_add_f32 v[120:121], v[120:121], v[108:109]
    v_pk_add_f32 v[122:123], v[122:123], v[110:111]
    v_pk_add_f32 v[124:125], v[124:125], v[112:113]
    v_pk_add_f32 v[126:127], v[126:127], v[114:115]
    s_waitcnt vmcnt(10)
    v_lshlrev_b32 v108, 16, v92
    v_and_b32 v109, 0xffff0000, v92
    v_lshlrev_b32 v110, 16, v93
    v_and_b32 v111, 0xffff0000, v93
    v_lshlrev_b32 v112, 16, v94
    v_and_b32 v113, 0xffff0000, v94
    v_lshlrev_b32 v114, 16, v95
    v_and_b32 v115, 0xffff0000, v95
    v_pk_add_f32 v[120:121], v[120:121], v[108:109]
    v_pk_add_f32 v[122:123], v[122:123], v[110:111]
    v_pk_add_f32 v[124:125], v[124:125], v[112:113]
    v_pk_add_f32 v[126:127], v[126:127], v[114:115]
    s_waitcnt vmcnt(9)
    v_lshlrev_b32 v108, 16, v96
    v_and_b32 v109, 0xffff0000, v96
    v_lshlrev_b32 v110, 16, v97
    v_and_b32 v111, 0xffff0000, v97
    v_lshlrev_b32 v112, 16, v98
    v_and_b32 v113, 0xffff0000, v98
    v_lshlrev_b32 v114, 16, v99
    v_and_b32 v115, 0xffff0000, v99
    v_pk_add_f32 v[120:121], v[120:121], v[108:109]
    v_pk_add_f32 v[122:123], v[122:123], v[110:111]
    v_pk_add_f32 v[124:125], v[124:125], v[112:113]
    v_pk_add_f32 v[126:127], v[126:127], v[114:115]
    s_waitcnt vmcnt(8)
    v_lshlrev_b32 v108, 16, v100
    v_and_b32 v109, 0xffff0000, v100
    v_lshlrev_b32 v110, 16, v101
    v_and_b32 v111, 0xffff0000, v101
    v_lshlrev_b32 v112, 16, v102
    v_and_b32 v113, 0xffff0000, v102
    v_lshlrev_b32 v114, 16, v103
    v_and_b32 v115, 0xffff0000, v103
    v_pk_add_f32 v[120:121], v[120:121], v[108:109]
    v_pk_add_f32 v[122:123], v[122:123], v[110:111]
    v_pk_add_f32 v[124:125], v[124:125], v[112:113]
    v_pk_add_f32 v[126:127], v[126:127], v[114:115]
    s_waitcnt vmcnt(7)
    v_lshlrev_b32 v108, 16, v104
    v_and_b32 v109, 0xffff0000, v104
    v_lshlrev_b32 v110, 16, v105
    v_and_b32 v111, 0xffff0000, v105
    v_lshlrev_b32 v112, 16, v106
    v_and_b32 v113, 0xffff0000, v106
    v_lshlrev_b32 v114, 16, v107
    v_and_b32 v115, 0xffff0000, v107
    v_pk_add_f32 v[120:121], v[120:121], v[108:109]
    v_pk_add_f32 v[122:123], v[122:123], v[110:111]
    v_pk_add_f32 v[124:125], v[124:125], v[112:113]
    v_pk_add_f32 v[126:127], v[126:127], v[114:115]
    v_lshlrev_b32 v14, 5, v0
    v_add_u32 v14, 65536, v14
    ds_write_b128 v14, v[120:123]
    ds_write_b128 v14, v[124:127] offset:16
    v_mov_b32 v14, 0
    v_mov_b32 v15, 0
    v_mov_b32 v13, 0x3f803f80
    s_waitcnt vmcnt(0)
    v_dot2c_f32_bf16 v14, v24, v13
    v_dot2c_f32_bf16 v15, v24, v24
    v_dot2c_f32_bf16 v14, v25, v13
    v_dot2c_f32_bf16 v15, v25, v25
    v_dot2c_f32_bf16 v14, v26, v13
    v_dot2c_f32_bf16 v15, v26, v26
    v_dot2c_f32_bf16 v14, v27, v13
    v_dot2c_f32_bf16 v15, v27, v27
    v_dot2c_f32_bf16 v14, v28, v13
    v_dot2c_f32_bf16 v15, v28, v28
    v_dot2c_f32_bf16 v14, v29, v13
    v_dot2c_f32_bf16 v15, v29, v29
    v_dot2c_f32_bf16 v14, v30, v13
    v_dot2c_f32_bf16 v15, v30, v30
    v_dot2c_f32_bf16 v14, v31, v13
    v_dot2c_f32_bf16 v15, v31, v31
    v_dot2c_f32_bf16 v14, v32, v13
    v_dot2c_f32_bf16 v15, v32, v32
    v_dot2c_f32_bf16 v14, v33, v13
    v_dot2c_f32_bf16 v15, v33, v33
    v_dot2c_f32_bf16 v14, v34, v13
    v_dot2c_f32_bf16 v15, v34, v34
    v_dot2c_f32_bf16 v14, v35, v13
    v_dot2c_f32_bf16 v15, v35, v35
    v_dot2c_f32_bf16 v14, v36, v13
    v_dot2c_f32_bf16 v15, v36, v36
    v_dot2c_f32_bf16 v14, v37, v13
    v_dot2c_f32_bf16 v15, v37, v37
    v_dot2c_f32_bf16 v14, v38, v13
    v_dot2c_f32_bf16 v15, v38, v38
    v_dot2c_f32_bf16 v14, v39, v13
    v_dot2c_f32_bf16 v15, v39, v39
    v_dot2c_f32_bf16 v14, v40, v13
    v_dot2c_f32_bf16 v15, v40, v40
    v_dot2c_f32_bf16 v14, v41, v13
    v_dot2c_f32_bf16 v15, v41, v41
    v_dot2c_f32_bf16 v14, v42, v13
    v_dot2c_f32_bf16 v15, v42, v42
    v_dot2c_f32_bf16 v14, v43, v13
    v_dot2c_f32_bf16 v15, v43, v43
    v_dot2c_f32_bf16 v14, v44, v13
    v_dot2c_f32_bf16 v15, v44, v44
    v_dot2c_f32_bf16 v14, v45, v13
    v_dot2c_f32_bf16 v15, v45, v45
    v_dot2c_f32_bf16 v14, v46, v13
    v_dot2c_f32_bf16 v15, v46, v46
    v_dot2c_f32_bf16 v14, v47, v13
    v_dot2c_f32_bf16 v15, v47, v47
    v_dot2c_f32_bf16 v14, v48, v13
    v_dot2c_f32_bf16 v15, v48, v48
    v_dot2c_f32_bf16 v14, v49, v13
    v_dot2c_f32_bf16 v15, v49, v49
    v_dot2c_f32_bf16 v14, v50, v13
    v_dot2c_f32_bf16 v15, v50, v50
    v_dot2c_f32_bf16 v14, v51, v13
    v_dot2c_f32_bf16 v15, v51, v51
    s_nop 3
    v_add_f32_dpp v14, v14, v14 quad_perm:[1,0,3,2] row_mask:0xf bank_mask:0xf
    v_add_f32_dpp v15, v15, v15 quad_perm:[1,0,3,2] row_mask:0xf bank_mask:0xf
    s_nop 1
    v_add_f32_dpp v14, v14, v14 quad_perm:[2,3,0,1] row_mask:0xf bank_mask:0xf
    v_add_f32_dpp v15, v15, v15 quad_perm:[2,3,0,1] row_mask:0xf bank_mask:0xf
    s_nop 1
    v_add_f32_dpp v14, v14, v14 row_half_mirror row_mask:0xf bank_mask:0xf
    v_add_f32_dpp v15, v15, v15 row_half_mirror row_mask:0xf bank_mask:0xf
    s_nop 1
    s_mov_b32 s8, 0x3b124925
    s_mov_b32 s9, 0x3727c5ac
    v_mul_f32 v14, s8, v14
    v_mul_f32 v15, s8, v15
    v_fma_f32 v15, -v14, v14, v15
    v_max_f32 v15, 0, v15
    v_cvt_pk_bf16_f32 v15, v14, v15
    v_lshlrev_b32 v24, 16, v15
    v_and_b32 v15, 0xffff0000, v15
    v_add_f32 v15, s9, v15
    v_cvt_pk_bf16_f32 v15, v15, v15
    v_and_b32 v15, 0xffff0000, v15
    v_sqrt_f32 v15, v15
    s_nop 0
    v_cvt_pk_bf16_f32 v15, v15, v15
    v_and_b32 v15, 0xffff0000, v15
    v_rcp_f32 v25, v15
    v_lshlrev_b32 v9, 3, v9
    v_add_u32 v9, 98304, v9
    ds_write_b64 v9, v[24:25]
    s_waitcnt lgkmcnt(0)
    s_barrier
    s_cmp_lg_u32 s3, 7
    s_cbranch_scc1 P_KV
    s_setprio 3
    s_waitcnt vmcnt(0)
    buffer_load_dword v23, v20, s[56:59], 0 offen sc1
    v_lshlrev_b32 v10, 3, v2
    v_add_u32 v11, 65536, v10
    v_add_u32 v12, 98304, v10
    ds_read_b64 v[24:25], v12
    ds_read_b64 v[52:53], v11 offset:0
    ds_read_b64 v[54:55], v11 offset:512
    ds_read_b64 v[56:57], v11 offset:1024
    ds_read_b64 v[58:59], v11 offset:1536
    ds_read_b64 v[60:61], v11 offset:2048
    ds_read_b64 v[62:63], v11 offset:2560
    ds_read_b64 v[64:65], v11 offset:3072
    ds_read_b64 v[66:67], v11 offset:3584
    ds_read_b64 v[68:69], v11 offset:4096
    ds_read_b64 v[70:71], v11 offset:4608
    ds_read_b64 v[72:73], v11 offset:5120
    ds_read_b64 v[74:75], v11 offset:5632
    ds_read_b64 v[76:77], v11 offset:6144
    ds_read_b64 v[78:79], v11 offset:6656
    ds_read_b64 v[80:81], v11 offset:7168
    ds_read_b64 v[82:83], v11 offset:7680
    ds_read_b64 v[84:85], v11 offset:8192
    ds_read_b64 v[86:87], v11 offset:8704
    ds_read_b64 v[88:89], v11 offset:9216
    ds_read_b64 v[90:91], v11 offset:9728
    ds_read_b64 v[92:93], v11 offset:10240
    ds_read_b64 v[94:95], v11 offset:10752
    ds_read_b64 v[96:97], v11 offset:11264
    ds_read_b64 v[98:99], v11 offset:11776
    ds_read_b64 v[100:101], v11 offset:12288
    ds_read_b64 v[102:103], v11 offset:12800
    ds_read_b64 v[104:105], v11 offset:13312
    ds_read_b64 v[106:107], v11 offset:13824
    ds_read_b64 v[108:109], v11 offset:14336
    ds_read_b64 v[110:111], v11 offset:14848
    ds_read_b64 v[112:113], v11 offset:15360
    ds_read_b64 v[114:115], v11 offset:15872
    s_lshl_b32 s7, s12, 9
    s_add_u32 s7, s7, 12582912
    v_lshrrev_b32 v11, 3, v2
    v_lshlrev_b32 v11, 7, v11
    v_and_b32 v12, 7, v2
    v_lshl_add_u32 v11, v12, 3, v11
    s_lshl_b32 s8, s6, 10
    s_cmp_ge_u32 s13, 14
    s_cselect_b32 s9, 64, 0
    s_add_u32 s8, s8, s9
    s_add_u32 s8, s8, 12599296
    s_cmp_ge_u32 s13, 28
    s_cselect_b32 s8, 0x7f000000, s8
    s_waitcnt lgkmcnt(0)
    buffer_store_dwordx2 v[24:25], v10, s[52:55], s7 offen sc1
    v_pk_add_f32 v[52:53], v[52:53], v[84:85]
    v_pk_add_f32 v[54:55], v[54:55], v[86:87]
    v_pk_add_f32 v[56:57], v[56:57], v[88:89]
    v_pk_add_f32 v[58:59], v[58:59], v[90:91]
    v_pk_add_f32 v[60:61], v[60:61], v[92:93]
    v_pk_add_f32 v[62:63], v[62:63], v[94:95]
    v_pk_add_f32 v[64:65], v[64:65], v[96:97]
    v_pk_add_f32 v[66:67], v[66:67], v[98:99]
    v_pk_add_f32 v[68:69], v[68:69], v[100:101]
    v_pk_add_f32 v[70:71], v[70:71], v[102:103]
    v_pk_add_f32 v[72:73], v[72:73], v[104:105]
    v_pk_add_f32 v[74:75], v[74:75], v[106:107]
    v_pk_add_f32 v[76:77], v[76:77], v[108:109]
    v_pk_add_f32 v[78:79], v[78:79], v[110:111]
    v_pk_add_f32 v[80:81], v[80:81], v[112:113]
    v_pk_add_f32 v[82:83], v[82:83], v[114:115]
    v_pk_add_f32 v[52:53], v[52:53], v[68:69]
    v_pk_add_f32 v[54:55], v[54:55], v[70:71]
    v_pk_add_f32 v[56:57], v[56:57], v[72:73]
    v_pk_add_f32 v[58:59], v[58:59], v[74:75]
    v_pk_add_f32 v[60:61], v[60:61], v[76:77]
    v_pk_add_f32 v[62:63], v[62:63], v[78:79]
    v_pk_add_f32 v[64:65], v[64:65], v[80:81]
    v_pk_add_f32 v[66:67], v[66:67], v[82:83]
    v_pk_add_f32 v[52:53], v[52:53], v[60:61]
    v_pk_add_f32 v[54:55], v[54:55], v[62:63]
    v_pk_add_f32 v[56:57], v[56:57], v[64:65]
    v_pk_add_f32 v[58:59], v[58:59], v[66:67]
    v_pk_add_f32 v[52:53], v[52:53], v[56:57]
    v_pk_add_f32 v[54:55], v[54:55], v[58:59]
    v_pk_add_f32 v[52:53], v[52:53], v[54:55]
    buffer_store_dwordx2 v[52:53], v11, s[52:55], s8 offen sc1
    s_mov_b32 s42, 0
P_TAGL:
    s_waitcnt vmcnt(0)
    v_readfirstlane_b32 s43, v23
    s_add_u32 s42, s42, 1
    s_cmp_gt_u32 s42, 0x4000
    s_cbranch_scc1 P_TAGOK
    s_cmp_lg_u32 s43, 0
    s_cbranch_scc1 P_TAGOK
    s_sleep 4
    buffer_load_dword v23, v20, s[56:59], 0 offen sc1
    s_branch P_TAGL
P_TAGOK:
    s_lshl_b32 s7, s12, 7
    s_add_u32 s7, s7, 12746752
    s_lshl_b32 s8, s13, 7
    s_add_u32 s8, s8, 12750848
    s_mov_b64 exec, 1
    buffer_store_dword v23, v20, s[52:55], s7 offen sc1
    buffer_store_dword v23, v20, s[52:55], s8 offen sc1
    s_mov_b64 exec, -1
P_KV:
    s_barrier
    s_mov_b32 s60, s34
    s_and_b32 s61, s35, 0xffff
    s_mov_b32 s62, 1605632
    s_mov_b32 s63, 0x20000
    s_lshr_b32 s5, s4, 3
    s_mul_i32 s5, s5, 401408
    s_add_u32 s9, s5, 200704
    v_lshlrev_b32 v9, 7, v0
    s_add_u32 s8, s5, 0
    buffer_load_dword v10, v9, s[60:63], s8 offen
    s_add_u32 s8, s5, 65536
    buffer_load_dword v10, v9, s[60:63], s8 offen
    s_add_u32 s8, s5, 131072
    buffer_load_dword v10, v9, s[60:63], s8 offen
    s_add_u32 s8, s5, 196608
    buffer_load_dword v10, v9, s[60:63], s8 offen
    s_add_u32 s8, s5, 262144
    buffer_load_dword v10, v9, s[60:63], s8 offen
    s_add_u32 s8, s5, 327680
    buffer_load_dword v10, v9, s[60:63], s8 offen
    s_add_u32 s8, s5, 393216
    v_cmp_gt_u32 vcc, 64, v0
    s_and_saveexec_b64 s[10:11], vcc
    s_cbranch_execz P_PF1
    buffer_load_dword v10, v9, s[60:63], s8 offen
P_PF1:
    s_mov_b64 exec, s[10:11]
    s_endpgm
K_END:
    s_endpgm
.section .rodata,"a"
.p2align 6
.amdhsa_kernel recurrent_scan__ssm_conv_h3__glu_gated_reglu__prompt_kernel
  .amdhsa_next_free_vgpr 256
  .amdhsa_next_free_sgpr 102
  .amdhsa_accum_offset 256
  .amdhsa_group_segment_fixed_size 0
  .amdhsa_kernarg_size 104
  .amdhsa_user_sgpr_count 2
  .amdhsa_user_sgpr_kernarg_segment_ptr 1
  .amdhsa_system_sgpr_workgroup_id_x 1
  .amdhsa_float_denorm_mode_32 3
.end_amdhsa_kernel
```
